```python
import torch

def _softmax(x, axis=-1):
    return torch.softmax(x, dim=axis)
def _gelu(x):
    return torch.nn.functional.gelu(x, approximate="tanh")
def _silu(x):
    return torch.nn.functional.silu(x)
def _sigmoid(x):
    return torch.sigmoid(x)
def _layernorm(x, axis=-1, eps=1e-5):
    m = x.mean(dim=axis, keepdim=True)
    v = x.var(dim=axis, keepdim=True, unbiased=False)
    return (x - m) / torch.sqrt(v + eps)
def _scatter_add(tgt, idx, src, axis=0):
    return tgt.clone().index_add_(axis, idx, src)
def _segment_sum(src, seg, n):
    out = torch.zeros((n,) + src.shape[1:], dtype=src.dtype)
    return out.index_add_(0, seg, src)
def _pad(x, pw):
    flat = tuple(v for pair in reversed(pw) for v in pair)
    return torch.nn.functional.pad(x, flat)

kernel_name = 'recurrent_scan__sliding_block_cached__swiglu_ffn__decode'

def setup_inputs():

    _w = (lambda a: (lambda t: t.to(torch.bfloat16) if t.is_floating_point() else t)(torch.as_tensor(a)))
    def _A_setup():
        B, Sq, D = 2, 1, 512
        Hq, Hkv, Sk, Dh = 32, 8, 32768, 128
        assert Hq % Hkv == 0, (Hq, Hkv)
        return {
            "x": _w((lambda *s: torch.randn(*s, dtype=torch.bfloat16) * 0.05)(B, Sq, D)),
            "k_cache": _w((lambda *s: torch.randn(*s, dtype=torch.bfloat16) * 1.6)(B, Hkv, Sk, Dh)),
            "v_cache": _w((lambda *s: torch.randn(*s, dtype=torch.bfloat16) * 0.2)(B, Hkv, Sk, Dh)),
            "wq": _w((lambda *s: torch.randn(*s, dtype=torch.bfloat16) * 1.6)(D, Hq * Dh) * (D ** -0.5)),
            "wo": _w((lambda *s: torch.randn(*s, dtype=torch.bfloat16) * 0.2)(Hq * Dh, D) * ((Hq * Dh) ** -0.5)),
        }
    _A_in = _A_setup()

    def _B_setup():
        B, S, D, F = 2, 1, 512, 1792
        return {
            "x": _w((lambda *s: torch.randn(*s, dtype=torch.bfloat16) * 0.05)(B, S, D)),
            "w_gate": _w((lambda *s: torch.randn(*s, dtype=torch.bfloat16) * 0.1)(D, F)),
            "w_up": _w((lambda *s: torch.randn(*s, dtype=torch.bfloat16) * 0.1)(D, F)),
            "w_down": _w((lambda *s: torch.randn(*s, dtype=torch.bfloat16) * 0.1)(F, D)),
        }
    _B_in = _B_setup()

    return {
        "A_x": _A_in["x"],
        "A_k_cache": _A_in["k_cache"],
        "A_v_cache": _A_in["v_cache"],
        "A_wq": _A_in["wq"],
        "A_wo": _A_in["wo"],
        "B_x": _B_in["x"],
        "B_w_gate": _B_in["w_gate"],
        "B_w_up": _B_in["w_up"],
        "B_w_down": _B_in["w_down"],
    }

def reference(A_x, A_k_cache, A_v_cache, A_wq, A_wo, B_x, B_w_gate, B_w_up, B_w_down):
    def _A_ref(x, k_cache, v_cache, wq, wo):
        B, Sq, D = x.shape
        Hq, Dh = 32, 128
        Hkv, Sk = k_cache.shape[1], k_cache.shape[2]
        W = min(4096, max(256, Sk // 4))
        rep = Hq // Hkv
        q = (lambda x, *d: x.permute(*d))((x @ wq).reshape(B, Sq, Hq, Dh), 0, 2, 1, 3)
        k = (lambda x, n, axis: torch.repeat_interleave(x, n, dim=axis))(k_cache[:, :, Sk - W:, :], rep, axis=1)
        v = (lambda x, n, axis: torch.repeat_interleave(x, n, dim=axis))(v_cache[:, :, Sk - W:, :], rep, axis=1)
        scores = torch.einsum("bhqd,bhkd->bhqk", q, k) * (Dh ** -0.5)
        p = _softmax(scores, axis=-1)
        o = torch.einsum("bhqk,bhkd->bhqd", p, v)
        return (lambda x, *d: x.permute(*d))(o, 0, 2, 1, 3).reshape(B, Sq, Hq * Dh) @ wo

    def _B_ref(x, w_gate, w_up, w_down):
        g = _silu(x @ w_gate)
        u = x @ w_up
        return (g * u) @ w_down

    x = A_x
    xn = _layernorm(x, axis=-1)
    s = _A_ref(xn, A_k_cache, A_v_cache, A_wq, A_wo)
    g = _silu(_B_ref(xn, B_w_gate, B_w_up, B_w_down))
    return x + s * g
```

```asm
; @launch grid=(256,1,1) block=(640,1,1) lds=82944
.amdgcn_target "amdgcn-amd-amdhsa--gfx950"
.text
.globl recurrent_scan__sliding_block_cached__swiglu_ffn__decode_kernel
.p2align 8
.type recurrent_scan__sliding_block_cached__swiglu_ffn__decode_kernel,@function
recurrent_scan__sliding_block_cached__swiglu_ffn__decode_kernel:
L_entry:
    s_load_dwordx16 s[4:19], s[0:1], 0
    s_lshr_b32 s30, s2, 3
    s_cmp_ge_u32 s30, 32
    s_cbranch_scc1 L_end
    s_load_dwordx8 s[20:27], s[0:1], 64
    v_lshrrev_b32 v2, 6, v0
    v_and_b32 v1, 63, v0
    v_readfirstlane_b32 s28, v2
    s_and_b32 s29, s2, 7
    v_lshlrev_b32 v3, 4, v1
    s_cmp_lg_u32 s28, 9
    s_cbranch_scc1 L_nopre
    s_getpc_b64 s[52:53]
L_pc:
    s_and_b32 s37, s30, 15
    v_lshl_add_u32 v5, s37, 10, v3
    v_min_u32 v5, L_codeend-L_pc-16, v5
    global_load_dwordx4 v[124:127], v5, s[52:53]
L_nopre:
    s_mov_b32 s43, 0x00020000
    s_cmp_ge_u32 s28, 2
    s_cbranch_scc1 L_A
    v_lshrrev_b32 v4, 3, v1
    v_and_b32 v5, 7, v1
    v_lshlrev_b32 v5, 4, v5
    s_movk_i32 s42, 2048
    s_mov_b32 s47, s43
    s_cmp_eq_u32 s28, 1
    s_cbranch_scc1 L_P1
    v_lshl_add_u32 v2, v4, 13, v5
    s_lshr_b32 s61, s30, 3
    s_lshl_b32 s62, s61, 10
    s_add_u32 s62, s62, s29
    s_and_b32 s37, s30, 7
    s_lshl3_add_u32 s62, s62, s37
    s_lshl_b32 s62, s62, 7
    s_bfm_b32 s63, 1, 16
    s_bfm_b32 s46, 1, 22
    s_waitcnt lgkmcnt(0)
    s_mov_b64 s[40:41], s[4:5]
    s_mov_b64 s[44:45], s[10:11]
    buffer_load_dwordx4 v[72:75], v3, s[40:43], 0 offen
    buffer_load_dwordx4 v[76:79], v3, s[40:43], 0 offen offset:1024
    buffer_load_dwordx4 v[8:11], v2, s[44:47], s62 offen nt
    s_add_u32 s62, s62, s63
    buffer_load_dwordx4 v[12:15], v2, s[44:47], s62 offen nt
    s_add_u32 s62, s62, s63
    buffer_load_dwordx4 v[16:19], v2, s[44:47], s62 offen nt
    s_add_u32 s62, s62, s63
    buffer_load_dwordx4 v[20:23], v2, s[44:47], s62 offen nt
    s_add_u32 s62, s62, s63
    buffer_load_dwordx4 v[24:27], v2, s[44:47], s62 offen nt
    s_add_u32 s62, s62, s63
    buffer_load_dwordx4 v[28:31], v2, s[44:47], s62 offen nt
    s_add_u32 s62, s62, s63
    buffer_load_dwordx4 v[32:35], v2, s[44:47], s62 offen nt
    s_add_u32 s62, s62, s63
    buffer_load_dwordx4 v[36:39], v2, s[44:47], s62 offen nt
    s_add_u32 s62, s62, s63
    buffer_load_dwordx4 v[40:43], v2, s[44:47], s62 offen nt
    s_add_u32 s62, s62, s63
    buffer_load_dwordx4 v[44:47], v2, s[44:47], s62 offen nt
    s_add_u32 s62, s62, s63
    buffer_load_dwordx4 v[48:51], v2, s[44:47], s62 offen nt
    s_add_u32 s62, s62, s63
    buffer_load_dwordx4 v[52:55], v2, s[44:47], s62 offen nt
    s_add_u32 s62, s62, s63
    buffer_load_dwordx4 v[56:59], v2, s[44:47], s62 offen nt
    s_add_u32 s62, s62, s63
    buffer_load_dwordx4 v[60:63], v2, s[44:47], s62 offen nt
    s_add_u32 s62, s62, s63
    buffer_load_dwordx4 v[64:67], v2, s[44:47], s62 offen nt
    s_add_u32 s62, s62, s63
    buffer_load_dwordx4 v[68:71], v2, s[44:47], s62 offen nt
    s_load_dwordx4 s[32:35], s[26:27], 0
    s_barrier
    s_setprio 3
    s_branch L_P0_main
L_P1:
    v_lshlrev_b32 v6, 2, v1
    v_mov_b32 v8, 0
    ds_write_b32 v6, v8 offset:22016
    ds_write_b32 v6, v8 offset:22528
    ds_write_b32 v6, v8 offset:22784
    v_cmp_gt_u32 vcc, 4, v1
    v_mov_b32 v7, 0xff800000
    s_mov_b64 exec, 0xffff
    v_cndmask_b32 v8, v8, v7, vcc
    ds_write_b32 v6, v8 offset:22272
    s_mov_b64 exec, -1
    s_waitcnt lgkmcnt(0)
    s_barrier
    v_mul_u32_u24 v2, 3584, v4
    v_add_u32 v2, v2, v5
    s_mov_b32 s56, 0x543b1c03
    s_mov_b32 s57, 0xc4ab8c73
    s_lshl_b32 s37, s29, 3
    s_lshr_b64 s[56:57], s[56:57], s37
    s_and_b32 s57, s56, 7
    s_bfe_u32 s56, s56, 0x50003
    s_bfe_u32 s58, s30, 0x20002
    s_add_u32 s38, s56, s58
    s_lshl_b32 s38, s38, 7
    s_and_b32 s61, s30, 3
    s_mul_i32 s62, s61, 458752
    s_add_u32 s62, s62, s38
    s_movk_i32 s63, 28672
    s_mov_b32 s46, 1835008
    s_cmp_ge_u32 s30, 16
    s_cselect_b64 s[44:45], s[18:19], s[16:17]
    s_mov_b64 s[40:41], s[4:5]
    s_load_dwordx4 s[32:35], s[26:27], 0
    s_setprio 0
    s_cmp_ge_u32 s58, s57
    s_cbranch_scc1 L_P1_nogu
    buffer_load_dwordx4 v[72:75], v3, s[40:43], 0 offen
    buffer_load_dwordx4 v[76:79], v3, s[40:43], 0 offen offset:1024
    buffer_load_dwordx4 v[8:11], v2, s[44:47], s62 offen nt
    s_add_u32 s62, s62, s63
    buffer_load_dwordx4 v[12:15], v2, s[44:47], s62 offen nt
    s_add_u32 s62, s62, s63
    buffer_load_dwordx4 v[16:19], v2, s[44:47], s62 offen nt
    s_add_u32 s62, s62, s63
    buffer_load_dwordx4 v[20:23], v2, s[44:47], s62 offen nt
    s_add_u32 s62, s62, s63
    buffer_load_dwordx4 v[24:27], v2, s[44:47], s62 offen nt
    s_add_u32 s62, s62, s63
    buffer_load_dwordx4 v[28:31], v2, s[44:47], s62 offen nt
    s_add_u32 s62, s62, s63
    s_waitcnt vmcnt(7)
    buffer_load_dwordx4 v[32:35], v2, s[44:47], s62 offen nt
    s_add_u32 s62, s62, s63
    s_waitcnt vmcnt(7)
    buffer_load_dwordx4 v[36:39], v2, s[44:47], s62 offen nt
    s_add_u32 s62, s62, s63
    s_waitcnt vmcnt(7)
    buffer_load_dwordx4 v[40:43], v2, s[44:47], s62 offen nt
    s_add_u32 s62, s62, s63
    s_waitcnt vmcnt(7)
    buffer_load_dwordx4 v[44:47], v2, s[44:47], s62 offen nt
    s_add_u32 s62, s62, s63
    s_waitcnt vmcnt(7)
    buffer_load_dwordx4 v[48:51], v2, s[44:47], s62 offen nt
    s_add_u32 s62, s62, s63
    s_waitcnt vmcnt(7)
    buffer_load_dwordx4 v[52:55], v2, s[44:47], s62 offen nt
    s_add_u32 s62, s62, s63
    s_waitcnt vmcnt(7)
    buffer_load_dwordx4 v[56:59], v2, s[44:47], s62 offen nt
    s_add_u32 s62, s62, s63
    s_waitcnt vmcnt(7)
    buffer_load_dwordx4 v[60:63], v2, s[44:47], s62 offen nt
    s_add_u32 s62, s62, s63
    s_waitcnt vmcnt(7)
    buffer_load_dwordx4 v[64:67], v2, s[44:47], s62 offen nt
    s_add_u32 s62, s62, s63
    s_waitcnt vmcnt(7)
    buffer_load_dwordx4 v[68:71], v2, s[44:47], s62 offen nt
    s_branch L_P1_main
L_A:
    s_sub_u32 s28, s28, 2
    s_lshr_b32 s39, s30, 4
    s_lshl3_add_u32 s37, s39, s29
    s_lshl_b32 s37, s37, 6
    s_add_u32 s37, s37, s28
    s_lshl_b32 s61, s37, 17
    s_add_u32 s61, s61, 0x700000
    s_mul_i32 s38, s28, 10
    s_add_u32 s38, s38, s30
    s_and_b32 s62, s38, 15
    s_lshl_b32 s62, s62, 12
    s_add_u32 s62, s62, s61
    v_and_b32 v2, 2, v1
    v_lshlrev_b32 v2, 10, v2
    v_and_b32 v4, 12, v1
    v_lshl_or_b32 v2, v4, 6, v2
    v_and_b32 v4, 48, v1
    v_lshl_or_b32 v2, v4, 1, v2
    v_and_b32 v5, 1, v1
    v_lshl_or_b32 v2, v5, 4, v2
    s_bfm_b32 s42, 1, 27
    s_waitcnt lgkmcnt(0)
    s_mov_b64 s[40:41], s[6:7]
    s_barrier
    buffer_load_dwordx4 v[8:11], v2, s[40:43], s62 offen offset:0 nt
    buffer_load_dwordx4 v[12:15], v2, s[40:43], s62 offen offset:1024 nt
    buffer_load_dwordx4 v[16:19], v2, s[40:43], s62 offen offset:128 nt
    s_load_dwordx4 s[32:35], s[26:27], 0
    s_add_u32 s38, s38, 5
    s_and_b32 s63, s38, 15
    s_lshl_b32 s63, s63, 12
    s_add_u32 s63, s63, s61
    s_add_u32 s63, s63, 0x10000
    s_lshl_b32 s39, s39, 13
    s_lshl_b32 s38, s29, 14
    s_add_u32 s39, s39, s38
    s_lshl_b32 s38, s28, 8
    s_add_u32 s39, s39, s38
    s_add_u32 s39, s39, 65536
    v_and_b32 v5, 15, v1
    v_lshlrev_b32 v4, 7, v4
    v_lshl_or_b32 v4, v5, 4, v4
    s_mov_b64 s[44:45], s[8:9]
    s_mov_b64 s[46:47], s[42:43]
    s_mov_b64 s[48:49], s[26:27]
    s_mov_b32 s50, 0x20000000
    s_mov_b32 s51, 0x00020000
    v_mov_b32 v7, 0x3f
    v_mov_b32 v142, 0x7ff
    v_mov_b32 v134, 22272
    v_mov_b32 v136, 1
    s_lshr_b32 s31, s30, 3
    s_lshl2_add_u32 s31, s29, s31
    v_lshrrev_b32 v5, 4, v1
    v_add_u32 v128, v1, v5
    v_and_b32 v128, 15, v128
    v_lshl_add_u32 v128, v5, 4, v128
    v_lshlrev_b32 v128, 4, v128
    s_lshl_b32 s37, s28, 11
    v_add_u32 v128, s37, v128
    v_bfe_u32 v6, v1, 2, 2
    v_and_b32 v139, 3, v1
    v_lshl_add_u32 v129, v139, 2, v5
    v_add_u32 v129, v129, v6
    v_and_b32 v129, 15, v129
    v_lshl_add_u32 v129, v6, 4, v129
    v_lshlrev_b32 v129, 4, v129
    s_lshl_b32 s37, s28, 10
    v_add_u32 v129, s37, v129
    v_cmp_eq_u32 s[64:65], 0, v6
    v_cmp_eq_u32 s[66:67], 1, v6
    v_cmp_eq_u32 s[68:69], 2, v6
    v_cmp_eq_u32 s[70:71], 3, v6
    s_lshl_b32 s37, s28, 7
    s_add_u32 s37, s37, 16384
    v_lshlrev_b32 v137, 5, v139
    v_lshl_add_u32 v137, v5, 3, v137
    v_lshl_add_u32 v137, v6, 1, v137
    v_add_u32 v137, s37, v137
    v_lshlrev_b32 v138, 8, v139
    v_lshl_add_u32 v138, v5, 5, v138
    v_add_u32 v138, 16384, v138
    v_lshlrev_b32 v139, 2, v139
    s_lshl_b32 s37, s28, 4
    s_add_u32 s37, s37, 22336
    v_add_u32 v140, s37, v139
    v_and_b32 v6, 15, v1
    v_lshlrev_b32 v130, 4, v6
    v_lshl_add_u32 v130, v5, 14, v130
    s_lshl_b32 s56, s29, 16
    s_lshl_b32 s38, s30, 9
    s_add_u32 s56, s56, s38
    s_lshl_b32 s38, s28, 8
    s_add_u32 s56, s56, s38
    s_add_u32 s56, s56, 393216
    s_lshl_b32 s57, s29, 11
    s_lshl4_add_u32 s57, s30, s57
    s_add_u32 s57, s57, 327680
    s_lshr_b32 s36, s28, 2
    s_lshl_b32 s37, s36, 7
    s_and_b32 s38, s28, 1
    s_lshl_b32 s38, s38, 8
    s_add_u32 s37, s37, s38
    s_bfe_u32 s38, s28, 0x10001
    s_lshl_b32 s38, s38, 5
    s_add_u32 s37, s37, s38
    s_add_u32 s37, s37, 21504
    v_lshlrev_b32 v133, 1, v5
    v_add_u32 v133, s37, v133
    v_bfe_u32 v5, v1, 2, 1
    v_lshl_add_u32 v133, v5, 3, v133
    v_and_b32 v5, 1, v1
    v_lshl_add_u32 v133, v5, 6, v133
    v_bfe_u32 v5, v1, 1, 1
    v_lshl_add_u32 v133, v5, 4, v133
    v_lshrrev_b32 v5, 3, v1
    v_and_b32 v6, 7, v1
    v_lshlrev_b32 v131, 4, v6
    v_lshl_add_u32 v131, v5, 9, v131
    v_lshlrev_b32 v132, 2, v5
    s_lshl_b32 s58, s31, 14
    s_lshl_b32 s38, s36, 13
    s_add_u32 s58, s58, s38
    s_and_b32 s38, s28, 3
    s_lshl_b32 s38, s38, 7
    s_add_u32 s58, s58, s38
    s_add_u32 s58, s58, 393216
    s_add_u32 s59, s58, 4096
    s_lshl_b32 s55, s31, 9
    s_lshl_b32 s38, s36, 8
    s_add_u32 s55, s55, s38
    s_add_u32 s55, s55, 327680
    v_bfe_u32 v5, v1, 4, 1
    v_and_b32 v6, 15, v1
    v_lshlrev_b32 v141, 4, v6
    v_lshl_add_u32 v141, v5, 13, v141
    s_lshl_b32 s7, s29, 14
    s_lshl_b32 s38, s30, 8
    s_add_u32 s7, s7, s38
    s_add_u32 s7, s7, 65536
    s_mov_b32 s52, 0x3db504f3
    s_mov_b32 s53, 0x3fb8aa3b
    s_mov_b32 s54, 0xffff0000
    s_getreg_b32 s36, hwreg(HW_REG_XCC_ID, 0, 3)
    s_waitcnt lgkmcnt(0)
    s_add_u32 s32, s32, 0x2b5
    s_and_b32 s32, s32, 0x7ff
    s_add_u32 s33, s33, 0xd3
    s_and_b32 s33, s33, 0x7ff
    s_add_u32 s34, s34, 0x61f
    s_and_b32 s34, s34, 0x7ff
    s_add_u32 s35, s35, 0x3a9
    s_and_b32 s35, s35, 0x7ff
    s_xor_b32 s36, s36, s33
    s_lshl_b32 s8, s32, 11
    s_or_b32 s8, s8, s34
    s_lshl_b32 s37, s33, 22
    s_or_b32 s8, s8, s37
    s_lshl_b32 s9, s33, 11
    s_or_b32 s9, s9, s35
    s_lshl_b32 s37, s34, 22
    s_or_b32 s9, s9, s37
    s_waitcnt vmcnt(2)
    buffer_load_dwordx4 v[20:23], v2, s[40:43], s62 offen offset:1152 nt
    s_waitcnt vmcnt(2)
    buffer_load_dwordx4 v[24:27], v2, s[40:43], s63 offen offset:0 nt
    s_waitcnt vmcnt(2)
    buffer_load_dwordx4 v[28:31], v2, s[40:43], s63 offen offset:1024 nt
    s_waitcnt vmcnt(2)
    buffer_load_dwordx4 v[72:75], v4, s[48:51], s39 offen sc1
    s_waitcnt vmcnt(2)
    buffer_load_dwordx4 v[32:35], v2, s[40:43], s63 offen offset:128 nt
    s_waitcnt vmcnt(2)
    buffer_load_dwordx4 v[36:39], v2, s[40:43], s63 offen offset:1152 nt
    s_waitcnt vmcnt(2)
    buffer_load_dwordx4 v[40:43], v3, s[44:47], s62 offen offset:0 nt
    s_mov_b32 s60, 262144
    s_waitcnt vmcnt(3)
L_A_q:
    v_xor_b32 v88, s32, v72
    v_bitop3_b32 v88, v88, v74, s32 bitop3:0xf6
    v_xor_b32 v89, s36, v73
    v_bitop3_b32 v89, v89, v75, s36 bitop3:0xf6
    v_and_b32 v90, 0x38, v89
    v_and_or_b32 v88, v88, v7, v90
    v_cmp_ne_u32 vcc, 0, v88
    s_cbranch_vccz L_A_q_x
    s_sub_u32 s60, s60, 1
    s_cbranch_scc1 L_A_q_x
    s_and_b32 s37, s60, 1
    s_cbranch_scc1 L_A_q_n
    s_mov_b32 exec_lo, -1
    s_mov_b32 exec_hi, 0
    buffer_load_dwordx4 v[120:123], v141, s[48:51], s7 offen sc1
    s_waitcnt vmcnt(0)
    v_xor_b32 v108, s32, v120
    v_bitop3_b32 v108, v108, v122, s32 bitop3:0xf6
    v_bitop3_b32 v108, v108, v121, s36 bitop3:0xf6
    v_bitop3_b32 v108, v108, v123, s36 bitop3:0xf6
    v_and_b32 v108, v108, v7
    v_cmp_eq_u32 vcc, 0, v108
    s_and_b64 exec, exec, vcc
    s_cbranch_execz L_A_q_n_r
    buffer_store_dwordx4 v[120:123], v141, s[48:51], s7 offen sc1
L_A_q_n_r:
    s_mov_b64 exec, -1
L_A_q_n:
    buffer_load_dwordx4 v[72:75], v4, s[48:51], s39 offen sc1
    s_waitcnt vmcnt(0)
    s_branch L_A_q
L_A_q_x:
    v_and_b32 v89, 7, v89
    v_cmp_ne_u32 vcc, 0, v89
    s_cbranch_vccz L_A_samexcd
    ds_write_b32 v134, v136 offset:28
L_A_samexcd:
    v_permlane32_swap_b32 v72, v74
    v_permlane32_swap_b32 v73, v75
    v_add_f32 v72, v72, v74
    v_add_f32 v73, v73, v75
    s_nop 1
    v_permlane16_swap_b32 v72, v73
    v_add_f32 v72, v72, v73
    v_cvt_pk_bf16_f32 v72, v72, v72
    ds_write_b16 v137, v72
    s_mov_b64 exec, 1
    ds_add_u32 v134, v136 offset:20
    s_mov_b64 exec, -1
    s_waitcnt vmcnt(2)
    buffer_load_dwordx4 v[44:47], v3, s[44:47], s62 offen offset:1024 nt
    buffer_load_dwordx4 v[48:51], v3, s[44:47], s62 offen offset:2048 nt
    buffer_load_dwordx4 v[52:55], v3, s[44:47], s62 offen offset:3072 nt
    s_mov_b32 vcc_lo, 0x55555555
    s_mov_b32 vcc_hi, 0x55555555
    s_waitcnt vmcnt(4)
    v_cndmask_b32_dpp v112, v12, v8, vcc quad_perm:[1,0,3,2] row_mask:0xf bank_mask:0xf
    v_cndmask_b32_dpp v113, v13, v9, vcc quad_perm:[1,0,3,2] row_mask:0xf bank_mask:0xf
    v_cndmask_b32_dpp v114, v14, v10, vcc quad_perm:[1,0,3,2] row_mask:0xf bank_mask:0xf
    v_cndmask_b32_dpp v115, v15, v11, vcc quad_perm:[1,0,3,2] row_mask:0xf bank_mask:0xf
    v_cndmask_b32_dpp v116, v20, v16, vcc quad_perm:[1,0,3,2] row_mask:0xf bank_mask:0xf
    v_cndmask_b32_dpp v117, v21, v17, vcc quad_perm:[1,0,3,2] row_mask:0xf bank_mask:0xf
    v_cndmask_b32_dpp v118, v22, v18, vcc quad_perm:[1,0,3,2] row_mask:0xf bank_mask:0xf
    v_cndmask_b32_dpp v119, v23, v19, vcc quad_perm:[1,0,3,2] row_mask:0xf bank_mask:0xf
    v_cndmask_b32_dpp v120, v28, v24, vcc quad_perm:[1,0,3,2] row_mask:0xf bank_mask:0xf
    v_cndmask_b32_dpp v121, v29, v25, vcc quad_perm:[1,0,3,2] row_mask:0xf bank_mask:0xf
    v_cndmask_b32_dpp v122, v30, v26, vcc quad_perm:[1,0,3,2] row_mask:0xf bank_mask:0xf
    v_cndmask_b32_dpp v123, v31, v27, vcc quad_perm:[1,0,3,2] row_mask:0xf bank_mask:0xf
    v_cndmask_b32_dpp v124, v36, v32, vcc quad_perm:[1,0,3,2] row_mask:0xf bank_mask:0xf
    v_cndmask_b32_dpp v125, v37, v33, vcc quad_perm:[1,0,3,2] row_mask:0xf bank_mask:0xf
    v_cndmask_b32_dpp v126, v38, v34, vcc quad_perm:[1,0,3,2] row_mask:0xf bank_mask:0xf
    v_cndmask_b32_dpp v127, v39, v35, vcc quad_perm:[1,0,3,2] row_mask:0xf bank_mask:0xf
    s_not_b64 vcc, vcc
    v_cndmask_b32_dpp v12, v8, v12, vcc quad_perm:[1,0,3,2] row_mask:0xf bank_mask:0xf
    v_cndmask_b32_dpp v13, v9, v13, vcc quad_perm:[1,0,3,2] row_mask:0xf bank_mask:0xf
    v_cndmask_b32_dpp v14, v10, v14, vcc quad_perm:[1,0,3,2] row_mask:0xf bank_mask:0xf
    v_cndmask_b32_dpp v15, v11, v15, vcc quad_perm:[1,0,3,2] row_mask:0xf bank_mask:0xf
    v_cndmask_b32_dpp v20, v16, v20, vcc quad_perm:[1,0,3,2] row_mask:0xf bank_mask:0xf
    v_cndmask_b32_dpp v21, v17, v21, vcc quad_perm:[1,0,3,2] row_mask:0xf bank_mask:0xf
    v_cndmask_b32_dpp v22, v18, v22, vcc quad_perm:[1,0,3,2] row_mask:0xf bank_mask:0xf
    v_cndmask_b32_dpp v23, v19, v23, vcc quad_perm:[1,0,3,2] row_mask:0xf bank_mask:0xf
    v_cndmask_b32_dpp v28, v24, v28, vcc quad_perm:[1,0,3,2] row_mask:0xf bank_mask:0xf
    v_cndmask_b32_dpp v29, v25, v29, vcc quad_perm:[1,0,3,2] row_mask:0xf bank_mask:0xf
    v_cndmask_b32_dpp v30, v26, v30, vcc quad_perm:[1,0,3,2] row_mask:0xf bank_mask:0xf
    v_cndmask_b32_dpp v31, v27, v31, vcc quad_perm:[1,0,3,2] row_mask:0xf bank_mask:0xf
    v_cndmask_b32_dpp v36, v32, v36, vcc quad_perm:[1,0,3,2] row_mask:0xf bank_mask:0xf
    v_cndmask_b32_dpp v37, v33, v37, vcc quad_perm:[1,0,3,2] row_mask:0xf bank_mask:0xf
    v_cndmask_b32_dpp v38, v34, v38, vcc quad_perm:[1,0,3,2] row_mask:0xf bank_mask:0xf
    v_cndmask_b32_dpp v39, v35, v39, vcc quad_perm:[1,0,3,2] row_mask:0xf bank_mask:0xf
    s_mov_b32 s60, 1048576
L_A_qq:
    ds_read_b32 v108, v134 offset:20
    ds_read_b128 v[72:75], v138 offset:0
    ds_read_b128 v[76:79], v138 offset:16
    ds_read_b128 v[80:83], v138 offset:128
    ds_read_b128 v[84:87], v138 offset:144
    s_sub_u32 s60, s60, 1
    s_cbranch_scc1 L_A_qq_x
    s_waitcnt lgkmcnt(4)
    v_cmp_ne_u32 vcc, 8, v108
    s_cbranch_vccz L_A_qq_x
    s_waitcnt lgkmcnt(0)
    s_branch L_A_qq
L_A_qq_x:
    s_waitcnt lgkmcnt(3)
    v_mfma_f32_16x16x32_bf16 v[88:91], v[112:115], v[72:75], 0
    v_mfma_f32_16x16x32_bf16 v[92:95], v[120:123], v[72:75], 0
    s_waitcnt lgkmcnt(2)
    v_mfma_f32_16x16x32_bf16 v[88:91], v[12:15], v[76:79], v[88:91]
    v_mfma_f32_16x16x32_bf16 v[92:95], v[28:31], v[76:79], v[92:95]
    s_waitcnt lgkmcnt(1)
    v_mfma_f32_16x16x32_bf16 v[88:91], v[116:119], v[80:83], v[88:91]
    v_mfma_f32_16x16x32_bf16 v[92:95], v[124:127], v[80:83], v[92:95]
    s_waitcnt lgkmcnt(0)
    v_mfma_f32_16x16x32_bf16 v[88:91], v[20:23], v[84:87], v[88:91]
    v_mfma_f32_16x16x32_bf16 v[92:95], v[36:39], v[84:87], v[92:95]
    s_nop 7
    v_cvt_pk_bf16_f32 v98, v88, v89
    v_cvt_pk_bf16_f32 v99, v90, v91
    v_cvt_pk_bf16_f32 v100, v92, v93
    v_cvt_pk_bf16_f32 v101, v94, v95
    v_lshlrev_b32 v88, 16, v98
    v_and_b32 v89, s54, v98
    v_lshlrev_b32 v90, 16, v99
    v_and_b32 v91, s54, v99
    v_lshlrev_b32 v92, 16, v100
    v_and_b32 v93, s54, v100
    v_lshlrev_b32 v94, 16, v101
    v_and_b32 v95, s54, v101
    v_mul_f32 v88, s52, v88
    v_mul_f32 v89, s52, v89
    v_mul_f32 v90, s52, v90
    v_mul_f32 v91, s52, v91
    v_mul_f32 v92, s52, v92
    v_mul_f32 v93, s52, v93
    v_mul_f32 v94, s52, v94
    v_mul_f32 v95, s52, v95
    v_cvt_pk_bf16_f32 v98, v88, v89
    v_cvt_pk_bf16_f32 v99, v90, v91
    v_cvt_pk_bf16_f32 v100, v92, v93
    v_cvt_pk_bf16_f32 v101, v94, v95
    v_lshlrev_b32 v88, 16, v98
    v_and_b32 v89, s54, v98
    v_lshlrev_b32 v90, 16, v99
    v_and_b32 v91, s54, v99
    v_lshlrev_b32 v92, 16, v100
    v_and_b32 v93, s54, v100
    v_lshlrev_b32 v94, 16, v101
    v_and_b32 v95, s54, v101
    v_max3_f32 v96, v88, v89, v90
    v_max3_f32 v98, v91, v92, v93
    v_max3_f32 v96, v96, v94, v95
    v_max_f32 v96, v96, v98
    s_mov_b32 exec_lo, 0x000f000f
    s_mov_b32 exec_hi, 0x000f000f
    ds_max_f32 v139, v96 offset:22272
    s_mov_b64 exec, 1
    ds_add_u32 v134, v136 offset:16
    s_mov_b64 exec, -1
    buffer_load_dwordx4 v[56:59], v3, s[44:47], s63 offen offset:0 nt
    s_mov_b32 s60, 1048576
L_A_m:
    ds_read_b32 v108, v134 offset:16
    ds_read_b32 v96, v139 offset:22272
    s_sub_u32 s60, s60, 1
    s_cbranch_scc1 L_A_m_x
    s_waitcnt lgkmcnt(0)
    v_cmp_ne_u32 vcc, 8, v108
    s_cbranch_vccnz L_A_m
L_A_m_x:
    v_mul_f32 v96, s53, v96
    v_bfi_b32 v109, v7, s32, v96
    v_fma_f32 v88, v88, s53, -v109
    v_fma_f32 v89, v89, s53, -v109
    v_fma_f32 v90, v90, s53, -v109
    v_fma_f32 v91, v91, s53, -v109
    v_fma_f32 v92, v92, s53, -v109
    v_fma_f32 v93, v93, s53, -v109
    v_fma_f32 v94, v94, s53, -v109
    v_fma_f32 v95, v95, s53, -v109
    v_exp_f32 v88, v88
    v_exp_f32 v89, v89
    v_exp_f32 v90, v90
    v_exp_f32 v91, v91
    v_exp_f32 v92, v92
    v_exp_f32 v93, v93
    v_exp_f32 v94, v94
    v_exp_f32 v95, v95
    s_mov_b32 s6, 0
    v_add_f32 v110, v88, v89
    v_add_f32 v111, v90, v91
    v_add_f32 v112, v92, v93
    v_add_f32 v113, v94, v95
    v_add_f32 v110, v110, v111
    v_add_f32 v112, v112, v113
    v_add_f32 v110, v110, v112
    v_mov_b32 v111, v110
    s_nop 1
    v_permlane32_swap_b32 v110, v111
    v_add_f32 v110, v110, v111
    v_mov_b32 v111, v110
    s_nop 1
    v_permlane16_swap_b32 v110, v111
    v_add_f32 v110, v110, v111
    ds_write_b32 v140, v110
    s_mov_b64 exec, 1
    ds_add_rtn_u32 v111, v134, v136 offset:32
    s_mov_b64 exec, -1
    v_cvt_pk_bf16_f32 v96, v88, v89
    v_cvt_pk_bf16_f32 v97, v90, v91
    v_cvt_pk_bf16_f32 v98, v92, v93
    v_cvt_pk_bf16_f32 v99, v94, v95
    v_cndmask_b32 v72, 0, v96, s[64:65]
    v_cndmask_b32 v73, 0, v97, s[64:65]
    v_cndmask_b32 v74, 0, v98, s[64:65]
    v_cndmask_b32 v75, 0, v99, s[64:65]
    v_cndmask_b32 v76, 0, v96, s[66:67]
    v_cndmask_b32 v77, 0, v97, s[66:67]
    v_cndmask_b32 v78, 0, v98, s[66:67]
    v_cndmask_b32 v79, 0, v99, s[66:67]
    v_cndmask_b32 v80, 0, v96, s[68:69]
    v_cndmask_b32 v81, 0, v97, s[68:69]
    v_cndmask_b32 v82, 0, v98, s[68:69]
    v_cndmask_b32 v83, 0, v99, s[68:69]
    v_cndmask_b32 v84, 0, v96, s[70:71]
    v_cndmask_b32 v85, 0, v97, s[70:71]
    v_cndmask_b32 v86, 0, v98, s[70:71]
    v_cndmask_b32 v87, 0, v99, s[70:71]
    s_waitcnt lgkmcnt(0)
    v_readfirstlane_b32 s37, v111
    s_cmp_lg_u32 s37, 7
    s_cbranch_scc1 L_A_nostats
    ds_read_b32 v88, v139 offset:22336
    ds_read_b32 v89, v139 offset:22352
    ds_read_b32 v90, v139 offset:22368
    ds_read_b32 v91, v139 offset:22384
    ds_read_b32 v92, v139 offset:22400
    ds_read_b32 v93, v139 offset:22416
    ds_read_b32 v94, v139 offset:22432
    ds_read_b32 v95, v139 offset:22448
    ds_read_b32 v110, v134 offset:28
    v_lshlrev_b32 v111, 7, v139
    v_mov_b32 v96, v109
    v_mov_b32 v98, s8
    v_mov_b32 v99, s9
    s_waitcnt lgkmcnt(0)
    v_cmp_eq_u32 vcc, 0, v110
    v_add_f32 v88, v88, v89
    v_add_f32 v90, v90, v91
    v_add_f32 v92, v92, v93
    v_add_f32 v94, v94, v95
    v_add_f32 v88, v88, v90
    v_add_f32 v92, v92, v94
    v_add_f32 v88, v88, v92
    v_bfi_b32 v97, v7, s33, v88
    s_mov_b64 exec, 15
    s_setprio 3
    s_mov_b32 s6, 1
    s_cbranch_vccnz L_A_stfast
    buffer_store_dwordx4 v[96:99], v111, s[48:51], s57 offen sc1
    s_branch L_A_stdone
L_A_stfast:
    buffer_store_dwordx4 v[96:99], v111, s[48:51], s57 offen
L_A_stdone:
    s_mov_b64 exec, -1
    s_setprio 0
L_A_nostats:
    buffer_load_dwordx4 v[60:63], v3, s[44:47], s63 offen offset:1024 nt
    buffer_load_dwordx4 v[64:67], v3, s[44:47], s63 offen offset:2048 nt
    buffer_load_dwordx4 v[68:71], v3, s[44:47], s63 offen offset:3072 nt
    s_mov_b64 exec, 1
    ds_add_u32 v134, v136 offset:36
    s_mov_b64 exec, -1
    s_mov_b64 exec, 1
    ds_add_u32 v134, v136 offset:40
    s_mov_b64 exec, -1
    s_mov_b32 s37, 0x05040100
    s_mov_b32 s38, 0x07060302
    s_cmp_eq_u32 s6, 1
    s_cbranch_scc1 L_A_pv1
    s_waitcnt vmcnt(6)
    v_perm_b32 v8, v44, v40, s37
    v_perm_b32 v12, v44, v40, s38
    v_perm_b32 v16, v45, v41, s37
    v_perm_b32 v20, v45, v41, s38
    v_perm_b32 v24, v46, v42, s37
    v_perm_b32 v28, v46, v42, s38
    v_perm_b32 v32, v47, v43, s37
    v_perm_b32 v36, v47, v43, s38
    s_waitcnt vmcnt(4)
    v_perm_b32 v9, v52, v48, s37
    v_perm_b32 v13, v52, v48, s38
    v_perm_b32 v17, v53, v49, s37
    v_perm_b32 v21, v53, v49, s38
    v_perm_b32 v25, v54, v50, s37
    v_perm_b32 v29, v54, v50, s38
    v_perm_b32 v33, v55, v51, s37
    v_perm_b32 v37, v55, v51, s38
    s_waitcnt vmcnt(2)
    v_perm_b32 v10, v60, v56, s37
    v_perm_b32 v14, v60, v56, s38
    v_perm_b32 v18, v61, v57, s37
    v_perm_b32 v22, v61, v57, s38
    v_perm_b32 v26, v62, v58, s37
    v_perm_b32 v30, v62, v58, s38
    v_perm_b32 v34, v63, v59, s37
    v_perm_b32 v38, v63, v59, s38
    s_waitcnt vmcnt(0)
    s_branch L_A_pv2
L_A_pv1:
    s_waitcnt vmcnt(7)
    v_perm_b32 v8, v44, v40, s37
    v_perm_b32 v12, v44, v40, s38
    v_perm_b32 v16, v45, v41, s37
    v_perm_b32 v20, v45, v41, s38
    v_perm_b32 v24, v46, v42, s37
    v_perm_b32 v28, v46, v42, s38
    v_perm_b32 v32, v47, v43, s37
    v_perm_b32 v36, v47, v43, s38
    s_waitcnt vmcnt(5)
    v_perm_b32 v9, v52, v48, s37
    v_perm_b32 v13, v52, v48, s38
    v_perm_b32 v17, v53, v49, s37
    v_perm_b32 v21, v53, v49, s38
    v_perm_b32 v25, v54, v50, s37
    v_perm_b32 v29, v54, v50, s38
    v_perm_b32 v33, v55, v51, s37
    v_perm_b32 v37, v55, v51, s38
    s_waitcnt vmcnt(2)
    v_perm_b32 v10, v60, v56, s37
    v_perm_b32 v14, v60, v56, s38
    v_perm_b32 v18, v61, v57, s37
    v_perm_b32 v22, v61, v57, s38
    v_perm_b32 v26, v62, v58, s37
    v_perm_b32 v30, v62, v58, s38
    v_perm_b32 v34, v63, v59, s37
    v_perm_b32 v38, v63, v59, s38
    s_waitcnt vmcnt(0)
L_A_pv2:
    s_mov_b64 exec, 0xffff
    buffer_load_dwordx4 v[104:107], v3, s[48:51], s55 offen sc1
    s_mov_b64 exec, -1
    v_perm_b32 v11, v68, v64, s37
    v_perm_b32 v15, v68, v64, s38
    v_perm_b32 v19, v69, v65, s37
    v_perm_b32 v23, v69, v65, s38
    v_perm_b32 v27, v70, v66, s37
    v_perm_b32 v31, v70, v66, s38
    v_perm_b32 v35, v71, v67, s37
    v_perm_b32 v39, v71, v67, s38
    v_mfma_f32_16x16x32_bf16 v[112:115], v[8:11], v[72:75], 0
    v_mfma_f32_16x16x32_bf16 v[116:119], v[24:27], v[72:75], 0
    v_mfma_f32_16x16x32_bf16 v[112:115], v[12:15], v[76:79], v[112:115]
    v_mfma_f32_16x16x32_bf16 v[116:119], v[28:31], v[76:79], v[116:119]
    v_mfma_f32_16x16x32_bf16 v[112:115], v[16:19], v[80:83], v[112:115]
    v_mfma_f32_16x16x32_bf16 v[116:119], v[32:35], v[80:83], v[116:119]
    v_mfma_f32_16x16x32_bf16 v[112:115], v[20:23], v[84:87], v[112:115]
    v_mfma_f32_16x16x32_bf16 v[116:119], v[36:39], v[84:87], v[116:119]
    s_mov_b32 s60, 262144
    s_nop 5
    ds_write_b128 v128, v[112:115] offset:0
    ds_write_b128 v128, v[116:119] offset:1024
    s_cmp_gt_u32 s28, 1
    s_waitcnt lgkmcnt(0)
    s_barrier
    s_cbranch_scc1 L_A_gather
    ds_read_b128 v[8:11], v129 offset:0
    ds_read_b128 v[12:15], v129 offset:2048
    ds_read_b128 v[16:19], v129 offset:4096
    ds_read_b128 v[20:23], v129 offset:6144
    ds_read_b128 v[24:27], v129 offset:8192
    ds_read_b128 v[28:31], v129 offset:10240
    ds_read_b128 v[32:35], v129 offset:12288
    ds_read_b128 v[36:39], v129 offset:14336
    ds_read_b32 v40, v134 offset:28
    s_waitcnt lgkmcnt(7)
    v_pk_add_f32 v[8:9], v[8:9], v[12:13]
    v_pk_add_f32 v[10:11], v[10:11], v[14:15]
    s_waitcnt lgkmcnt(6)
    v_pk_add_f32 v[8:9], v[8:9], v[16:17]
    v_pk_add_f32 v[10:11], v[10:11], v[18:19]
    s_waitcnt lgkmcnt(5)
    v_pk_add_f32 v[8:9], v[8:9], v[20:21]
    v_pk_add_f32 v[10:11], v[10:11], v[22:23]
    s_waitcnt lgkmcnt(4)
    v_pk_add_f32 v[8:9], v[8:9], v[24:25]
    v_pk_add_f32 v[10:11], v[10:11], v[26:27]
    s_waitcnt lgkmcnt(3)
    v_pk_add_f32 v[8:9], v[8:9], v[28:29]
    v_pk_add_f32 v[10:11], v[10:11], v[30:31]
    s_waitcnt lgkmcnt(2)
    v_pk_add_f32 v[8:9], v[8:9], v[32:33]
    v_pk_add_f32 v[10:11], v[10:11], v[34:35]
    s_waitcnt lgkmcnt(1)
    v_pk_add_f32 v[8:9], v[8:9], v[36:37]
    v_pk_add_f32 v[10:11], v[10:11], v[38:39]
    s_waitcnt lgkmcnt(0)
    v_cmp_eq_u32 vcc, 0, v40
    v_bfi_b32 v8, v142, s32, v8
    v_bfi_b32 v9, v142, s33, v9
    v_bfi_b32 v10, v142, s34, v10
    v_bfi_b32 v11, v142, s35, v11
    s_cbranch_vccnz L_A_pubfast
    buffer_store_dwordx4 v[8:11], v130, s[48:51], s56 offen sc1
    s_branch L_A_pubdone
L_A_pubfast:
    buffer_store_dwordx4 v[8:11], v130, s[48:51], s56 offen
L_A_pubdone:
L_A_gather:
    s_barrier
    buffer_load_dwordx4 v[48:51], v131, s[48:51], s58 offen sc1
    buffer_load_dwordx4 v[52:55], v131, s[48:51], s59 offen sc1
    s_mov_b64 exec, 0xffff
    s_waitcnt vmcnt(2)
    s_branch L_A_chkS
L_A_pollS:
    s_sub_u32 s60, s60, 1
    s_cbranch_scc1 L_A_pollS_x
    s_and_b32 s37, s60, 63
    s_cbranch_scc1 L_A_s_n
    s_mov_b32 exec_lo, -1
    s_mov_b32 exec_hi, 0
    buffer_load_dwordx4 v[120:123], v141, s[48:51], s7 offen sc1
    s_waitcnt vmcnt(0)
    v_xor_b32 v108, s32, v120
    v_bitop3_b32 v108, v108, v122, s32 bitop3:0xf6
    v_bitop3_b32 v108, v108, v121, s36 bitop3:0xf6
    v_bitop3_b32 v108, v108, v123, s36 bitop3:0xf6
    v_and_b32 v108, v108, v7
    v_cmp_eq_u32 vcc, 0, v108
    s_and_b64 exec, exec, vcc
    s_cbranch_execz L_A_s_n_r
    buffer_store_dwordx4 v[120:123], v141, s[48:51], s7 offen sc1
L_A_s_n_r:
    s_mov_b64 exec, 0xffff
L_A_s_n:
    buffer_load_dwordx4 v[104:107], v3, s[48:51], s55 offen sc1
    s_waitcnt vmcnt(0)
L_A_chkS:
    v_xor_b32 v60, s32, v104
    v_bitop3_b32 v60, v60, v105, s33 bitop3:0xf6
    v_and_b32 v60, v60, v7
    v_bitop3_b32 v60, v60, v106, s8 bitop3:0xf6
    v_bitop3_b32 v60, v60, v107, s9 bitop3:0xf6
    v_cmp_ne_u32 vcc, 0, v60
    s_cbranch_vccnz L_A_pollS
L_A_pollS_x:
    v_mov_b32 v61, v104
    s_nop 1
    v_max_f32_dpp v61, v61, v61 row_ror:1 row_mask:0xf bank_mask:0xf
    s_nop 1
    v_max_f32_dpp v61, v61, v61 row_ror:2 row_mask:0xf bank_mask:0xf
    s_nop 1
    v_max_f32_dpp v61, v61, v61 row_ror:4 row_mask:0xf bank_mask:0xf
    s_nop 1
    v_max_f32_dpp v61, v61, v61 row_ror:8 row_mask:0xf bank_mask:0xf
    v_sub_f32 v61, v104, v61
    v_exp_f32 v61, v61
    s_mov_b32 s60, 262144
    v_mul_f32 v62, v61, v105
    s_nop 1
    v_add_f32_dpp v62, v62, v62 row_ror:1 row_mask:0xf bank_mask:0xf
    s_nop 1
    v_add_f32_dpp v62, v62, v62 row_ror:2 row_mask:0xf bank_mask:0xf
    s_nop 1
    v_add_f32_dpp v62, v62, v62 row_ror:4 row_mask:0xf bank_mask:0xf
    s_nop 1
    v_add_f32_dpp v62, v62, v62 row_ror:8 row_mask:0xf bank_mask:0xf
    v_rcp_f32 v62, v62
    s_nop 0
    v_mul_f32 v61, v61, v62
    s_mov_b64 exec, -1
    ds_bpermute_b32 v68, v132, v61
    ds_bpermute_b32 v70, v132, v61 offset:32
    s_waitcnt vmcnt(0)
L_A_pollB:
    v_xor_b32 v62, s32, v48
    v_xor_b32 v63, s32, v52
    v_bitop3_b32 v62, v62, v49, s33 bitop3:0xf6
    v_bitop3_b32 v63, v63, v53, s33 bitop3:0xf6
    v_bitop3_b32 v62, v62, v50, s34 bitop3:0xf6
    v_bitop3_b32 v63, v63, v54, s34 bitop3:0xf6
    v_bitop3_b32 v62, v62, v51, s35 bitop3:0xf6
    v_bitop3_b32 v63, v63, v55, s35 bitop3:0xf6
    v_bitop3_b32 v60, v62, v63, v142 bitop3:0xa8
    v_cmp_ne_u32 vcc, 0, v60
    s_cbranch_vccz L_A_pollB_x
    v_and_b32 v62, v62, v142
    v_cmp_ne_u32 s[64:65], 0, v62
    v_and_b32 v63, v63, v142
    v_cmp_ne_u32 s[66:67], 0, v63
    s_sub_u32 s60, s60, 1
    s_cbranch_scc1 L_A_pollB_x
    s_mov_b64 exec, s[64:65]
    s_cbranch_execz L_A_pollB_1
    buffer_load_dwordx4 v[48:51], v131, s[48:51], s58 offen sc1
L_A_pollB_1:
    s_mov_b64 exec, s[66:67]
    s_cbranch_execz L_A_pollB_2
    buffer_load_dwordx4 v[52:55], v131, s[48:51], s59 offen sc1
L_A_pollB_2:
    s_mov_b64 exec, -1
    s_waitcnt vmcnt(0)
    s_branch L_A_pollB
L_A_pollB_x:
    s_waitcnt lgkmcnt(0)
    v_pk_mul_f32 v[64:65], v[48:49], v[68:69] op_sel_hi:[1,0]
    v_pk_mul_f32 v[66:67], v[50:51], v[68:69] op_sel_hi:[1,0]
    v_pk_fma_f32 v[64:65], v[52:53], v[70:71], v[64:65] op_sel_hi:[1,0,1]
    v_pk_fma_f32 v[66:67], v[54:55], v[70:71], v[66:67] op_sel_hi:[1,0,1]
    s_nop 1
    v_permlane32_swap_b32 v64, v66
    v_permlane32_swap_b32 v65, v67
    v_pk_add_f32 v[64:65], v[64:65], v[66:67]
    s_nop 1
    v_permlane16_swap_b32 v64, v65
    v_add_f32 v64, v64, v65
    s_nop 1
    v_add_f32_dpp v64, v64, v64 row_ror:8 row_mask:0xf bank_mask:0xf
    v_cvt_pk_bf16_f32 v64, v64, v64
    ds_write_b16 v133, v64
    s_waitcnt lgkmcnt(0)
    s_barrier
    s_endpgm
L_P0_main:
    v_mov_b32 v7, 0x3f
    v_mov_b32 v152, 0x7ff
    s_lshr_b32 s31, s30, 3
    s_lshl_b32 s37, s29, 2
    s_add_u32 s31, s31, s37
    v_lshl_add_u32 v5, v4, 10, v5
    v_lshrrev_b32 v6, 4, v1
    v_lshlrev_b32 v6, 3, v6
    v_and_b32 v143, 7, v1
    v_add_u32 v6, v6, v143
    v_lshlrev_b32 v6, 4, v6
    s_mov_b32 s48, s26
    s_and_b32 s49, s27, 0xffff
    s_mov_b32 s50, 0x20000000
    s_mov_b32 s51, 0x00020000
    s_mov_b32 s52, s12
    s_and_b32 s53, s13, 0xffff
    s_mov_b32 s54, 0x400000
    s_mov_b32 s55, 0x00020000
    s_mov_b32 s56, s22
    s_and_b32 s57, s23, 0xffff
    s_mov_b32 s58, 0x800
    s_mov_b32 s59, 0x00020000
    s_lshl_b32 s37, s61, 9
    s_add_u32 s37, s37, 17408
    v_and_b32 v140, 3, v1
    v_lshlrev_b32 v140, 6, v140
    v_lshrrev_b32 v141, 4, v1
    v_lshl_add_u32 v140, v141, 4, v140
    v_add_u32 v140, s37, v140
    v_bfe_u32 v141, v1, 2, 2
    v_mov_b32 v142, 22528
    v_cmp_eq_u32 vcc, 0, v141
    s_nop 1
    v_cndmask_b32 v136, v142, v140, vcc
    v_cmp_eq_u32 vcc, 1, v141
    s_nop 1
    v_cndmask_b32 v137, v142, v140, vcc
    v_cmp_eq_u32 vcc, 2, v141
    s_nop 1
    v_cndmask_b32 v138, v142, v140, vcc
    v_cmp_eq_u32 vcc, 3, v141
    s_nop 1
    v_cndmask_b32 v139, v142, v140, vcc
    s_waitcnt vmcnt(16) lgkmcnt(0)
    s_add_u32 s32, s32, 0x2b5
    s_and_b32 s32, s32, 0x7ff
    s_add_u32 s33, s33, 0xd3
    s_and_b32 s33, s33, 0x7ff
    s_add_u32 s34, s34, 0x61f
    s_and_b32 s34, s34, 0x7ff
    s_add_u32 s35, s35, 0x3a9
    s_and_b32 s35, s35, 0x7ff
    s_mov_b32 s39, 0xffff0000
    v_lshlrev_b32 v80, 16, v72
    v_and_b32 v81, s39, v72
    v_lshlrev_b32 v82, 16, v73
    v_and_b32 v83, s39, v73
    v_lshlrev_b32 v84, 16, v74
    v_and_b32 v85, s39, v74
    v_lshlrev_b32 v86, 16, v75
    v_and_b32 v87, s39, v75
    v_lshlrev_b32 v88, 16, v76
    v_and_b32 v89, s39, v76
    v_lshlrev_b32 v90, 16, v77
    v_and_b32 v91, s39, v77
    v_lshlrev_b32 v92, 16, v78
    v_and_b32 v93, s39, v78
    v_lshlrev_b32 v94, 16, v79
    v_and_b32 v95, s39, v79
    v_add_f32 v96, v80, v81
    v_add_f32 v97, v88, v89
    v_add_f32 v96, v96, v82
    v_add_f32 v97, v97, v90
    v_add_f32 v96, v96, v83
    v_add_f32 v97, v97, v91
    v_add_f32 v96, v96, v84
    v_add_f32 v97, v97, v92
    v_add_f32 v96, v96, v85
    v_add_f32 v97, v97, v93
    v_add_f32 v96, v96, v86
    v_add_f32 v97, v97, v94
    v_add_f32 v96, v96, v87
    v_add_f32 v97, v97, v95
    s_nop 1
    v_permlane32_swap_b32 v96, v97
    v_add_f32 v96, v96, v97
    v_mov_b32 v98, v96
    s_nop 1
    v_permlane16_swap_b32 v96, v98
    v_add_f32 v96, v96, v98
    s_nop 1
    v_add_f32_dpp v96, v96, v96 row_ror:1 row_mask:0xf bank_mask:0xf
    s_nop 1
    v_add_f32_dpp v96, v96, v96 row_ror:2 row_mask:0xf bank_mask:0xf
    s_nop 1
    v_add_f32_dpp v96, v96, v96 row_ror:4 row_mask:0xf bank_mask:0xf
    s_nop 1
    v_add_f32_dpp v96, v96, v96 row_ror:8 row_mask:0xf bank_mask:0xf
    v_mul_f32 v96, 0x3b000000, v96
    s_nop 0
    v_readlane_b32 s64, v96, 0
    v_readlane_b32 s65, v96, 32
    v_cvt_pk_bf16_f32 v96, v96, v96
    v_lshlrev_b32 v96, 16, v96
    s_nop 0
    v_readlane_b32 s66, v96, 0
    v_readlane_b32 s67, v96, 32
    v_subrev_f32 v98, s64, v80
    v_subrev_f32 v99, s65, v88
    v_mul_f32 v96, v98, v98
    v_mul_f32 v97, v99, v99
    v_subrev_f32 v98, s64, v81
    v_subrev_f32 v99, s65, v89
    v_fmac_f32 v96, v98, v98
    v_fmac_f32 v97, v99, v99
    v_subrev_f32 v98, s64, v82
    v_subrev_f32 v99, s65, v90
    v_fmac_f32 v96, v98, v98
    v_fmac_f32 v97, v99, v99
    v_subrev_f32 v98, s64, v83
    v_subrev_f32 v99, s65, v91
    v_fmac_f32 v96, v98, v98
    v_fmac_f32 v97, v99, v99
    v_subrev_f32 v98, s64, v84
    v_subrev_f32 v99, s65, v92
    v_fmac_f32 v96, v98, v98
    v_fmac_f32 v97, v99, v99
    v_subrev_f32 v98, s64, v85
    v_subrev_f32 v99, s65, v93
    v_fmac_f32 v96, v98, v98
    v_fmac_f32 v97, v99, v99
    v_subrev_f32 v98, s64, v86
    v_subrev_f32 v99, s65, v94
    v_fmac_f32 v96, v98, v98
    v_fmac_f32 v97, v99, v99
    v_subrev_f32 v98, s64, v87
    v_subrev_f32 v99, s65, v95
    v_fmac_f32 v96, v98, v98
    v_fmac_f32 v97, v99, v99
    s_nop 1
    v_permlane32_swap_b32 v96, v97
    v_add_f32 v96, v96, v97
    v_mov_b32 v98, v96
    s_nop 1
    v_permlane16_swap_b32 v96, v98
    v_add_f32 v96, v96, v98
    s_nop 1
    v_add_f32_dpp v96, v96, v96 row_ror:1 row_mask:0xf bank_mask:0xf
    s_nop 1
    v_add_f32_dpp v96, v96, v96 row_ror:2 row_mask:0xf bank_mask:0xf
    s_nop 1
    v_add_f32_dpp v96, v96, v96 row_ror:4 row_mask:0xf bank_mask:0xf
    s_nop 1
    v_add_f32_dpp v96, v96, v96 row_ror:8 row_mask:0xf bank_mask:0xf
    v_mul_f32 v96, 0x3b000000, v96
    v_cvt_pk_bf16_f32 v96, v96, v96
    v_lshlrev_b32 v96, 16, v96
    v_add_f32 v96, 0x3727c5ac, v96
    v_cvt_pk_bf16_f32 v96, v96, v96
    v_lshlrev_b32 v96, 16, v96
    v_sqrt_f32 v96, v96
    s_nop 0
    v_cvt_pk_bf16_f32 v96, v96, v96
    v_lshlrev_b32 v96, 16, v96
    v_rcp_f32 v96, v96
    v_subrev_f32 v80, s66, v80
    v_subrev_f32 v81, s66, v81
    v_subrev_f32 v82, s66, v82
    v_subrev_f32 v83, s66, v83
    v_subrev_f32 v84, s66, v84
    v_subrev_f32 v85, s66, v85
    v_subrev_f32 v86, s66, v86
    v_subrev_f32 v87, s66, v87
    v_subrev_f32 v88, s67, v88
    v_subrev_f32 v89, s67, v89
    v_subrev_f32 v90, s67, v90
    v_subrev_f32 v91, s67, v91
    v_subrev_f32 v92, s67, v92
    v_subrev_f32 v93, s67, v93
    v_subrev_f32 v94, s67, v94
    v_subrev_f32 v95, s67, v95
    v_readlane_b32 s68, v96, 0
    v_readlane_b32 s69, v96, 32
    v_cvt_pk_bf16_f32 v72, v80, v81
    v_cvt_pk_bf16_f32 v73, v82, v83
    v_cvt_pk_bf16_f32 v74, v84, v85
    v_cvt_pk_bf16_f32 v75, v86, v87
    v_cvt_pk_bf16_f32 v76, v88, v89
    v_cvt_pk_bf16_f32 v77, v90, v91
    v_cvt_pk_bf16_f32 v78, v92, v93
    v_cvt_pk_bf16_f32 v79, v94, v95
    v_lshlrev_b32 v80, 16, v72
    v_and_b32 v81, s39, v72
    v_lshlrev_b32 v82, 16, v73
    v_and_b32 v83, s39, v73
    v_lshlrev_b32 v84, 16, v74
    v_and_b32 v85, s39, v74
    v_lshlrev_b32 v86, 16, v75
    v_and_b32 v87, s39, v75
    v_lshlrev_b32 v88, 16, v76
    v_and_b32 v89, s39, v76
    v_lshlrev_b32 v90, 16, v77
    v_and_b32 v91, s39, v77
    v_lshlrev_b32 v92, 16, v78
    v_and_b32 v93, s39, v78
    v_lshlrev_b32 v94, 16, v79
    v_and_b32 v95, s39, v79
    v_mul_f32 v80, s68, v80
    v_mul_f32 v81, s68, v81
    v_mul_f32 v82, s68, v82
    v_mul_f32 v83, s68, v83
    v_mul_f32 v84, s68, v84
    v_mul_f32 v85, s68, v85
    v_mul_f32 v86, s68, v86
    v_mul_f32 v87, s68, v87
    v_mul_f32 v88, s69, v88
    v_mul_f32 v89, s69, v89
    v_mul_f32 v90, s69, v90
    v_mul_f32 v91, s69, v91
    v_mul_f32 v92, s69, v92
    v_mul_f32 v93, s69, v93
    v_mul_f32 v94, s69, v94
    v_mul_f32 v95, s69, v95
    v_lshrrev_b32 v96, 3, v1
    v_lshlrev_b32 v96, 8, v96
    v_and_b32 v97, 7, v1
    v_lshl_add_u32 v96, v97, 1, v96
    v_cvt_pk_bf16_f32 v72, v80, v81
    v_cvt_pk_bf16_f32 v73, v82, v83
    v_cvt_pk_bf16_f32 v74, v84, v85
    v_cvt_pk_bf16_f32 v75, v86, v87
    v_cvt_pk_bf16_f32 v76, v88, v89
    v_cvt_pk_bf16_f32 v77, v90, v91
    v_cvt_pk_bf16_f32 v78, v92, v93
    v_cvt_pk_bf16_f32 v79, v94, v95
    ds_write_b16 v96, v72 offset:17408
    ds_write_b16_d16_hi v96, v72 offset:17472
    ds_write_b16 v96, v73 offset:17424
    ds_write_b16_d16_hi v96, v73 offset:17488
    ds_write_b16 v96, v74 offset:17440
    ds_write_b16_d16_hi v96, v74 offset:17504
    ds_write_b16 v96, v75 offset:17456
    ds_write_b16_d16_hi v96, v75 offset:17520
    ds_write_b16 v96, v76 offset:17536
    ds_write_b16_d16_hi v96, v76 offset:17600
    ds_write_b16 v96, v77 offset:17552
    ds_write_b16_d16_hi v96, v77 offset:17616
    ds_write_b16 v96, v78 offset:17568
    ds_write_b16_d16_hi v96, v78 offset:17632
    ds_write_b16 v96, v79 offset:17584
    ds_write_b16_d16_hi v96, v79 offset:17648
    s_waitcnt lgkmcnt(0)
    ds_read_b128 v[104:107], v136 offset:0
    ds_read_b128 v[108:111], v137 offset:0
    ds_read_b128 v[112:115], v138 offset:0
    ds_read_b128 v[116:119], v139 offset:0
    ds_read_b128 v[120:123], v136 offset:256
    ds_read_b128 v[124:127], v137 offset:256
    ds_read_b128 v[128:131], v138 offset:256
    ds_read_b128 v[132:135], v139 offset:256
    s_mov_b32 s37, 0x05040100
    s_mov_b32 s38, 0x07060302
    s_waitcnt vmcnt(14)
    v_perm_b32 v72, v12, v8, s37
    v_perm_b32 v76, v12, v8, s38
    v_perm_b32 v80, v13, v9, s37
    v_perm_b32 v84, v13, v9, s38
    v_perm_b32 v88, v14, v10, s37
    v_perm_b32 v92, v14, v10, s38
    v_perm_b32 v96, v15, v11, s37
    v_perm_b32 v100, v15, v11, s38
    s_waitcnt vmcnt(12)
    v_perm_b32 v73, v20, v16, s37
    v_perm_b32 v77, v20, v16, s38
    v_perm_b32 v81, v21, v17, s37
    v_perm_b32 v85, v21, v17, s38
    v_perm_b32 v89, v22, v18, s37
    v_perm_b32 v93, v22, v18, s38
    v_perm_b32 v97, v23, v19, s37
    v_perm_b32 v101, v23, v19, s38
    s_waitcnt vmcnt(10)
    v_perm_b32 v74, v28, v24, s37
    v_perm_b32 v78, v28, v24, s38
    v_perm_b32 v82, v29, v25, s37
    v_perm_b32 v86, v29, v25, s38
    v_perm_b32 v90, v30, v26, s37
    v_perm_b32 v94, v30, v26, s38
    v_perm_b32 v98, v31, v27, s37
    v_perm_b32 v102, v31, v27, s38
    s_waitcnt vmcnt(8)
    v_perm_b32 v75, v36, v32, s37
    v_perm_b32 v79, v36, v32, s38
    v_perm_b32 v83, v37, v33, s37
    v_perm_b32 v87, v37, v33, s38
    v_perm_b32 v91, v38, v34, s37
    v_perm_b32 v95, v38, v34, s38
    v_perm_b32 v99, v39, v35, s37
    v_perm_b32 v103, v39, v35, s38
    s_waitcnt lgkmcnt(0)
    v_mfma_f32_16x16x32_bf16 v[140:143], v[104:107], v[72:75], 0
    v_mfma_f32_16x16x32_bf16 v[144:147], v[104:107], v[88:91], 0
    v_mfma_f32_16x16x32_bf16 v[140:143], v[108:111], v[76:79], v[140:143]
    v_mfma_f32_16x16x32_bf16 v[144:147], v[108:111], v[92:95], v[144:147]
    v_mfma_f32_16x16x32_bf16 v[140:143], v[112:115], v[80:83], v[140:143]
    v_mfma_f32_16x16x32_bf16 v[144:147], v[112:115], v[96:99], v[144:147]
    v_mfma_f32_16x16x32_bf16 v[140:143], v[116:119], v[84:87], v[140:143]
    v_mfma_f32_16x16x32_bf16 v[144:147], v[116:119], v[100:103], v[144:147]
    s_waitcnt vmcnt(6)
    v_perm_b32 v72, v44, v40, s37
    v_perm_b32 v76, v44, v40, s38
    v_perm_b32 v80, v45, v41, s37
    v_perm_b32 v84, v45, v41, s38
    v_perm_b32 v88, v46, v42, s37
    v_perm_b32 v92, v46, v42, s38
    v_perm_b32 v96, v47, v43, s37
    v_perm_b32 v100, v47, v43, s38
    s_waitcnt vmcnt(4)
    v_perm_b32 v73, v52, v48, s37
    v_perm_b32 v77, v52, v48, s38
    v_perm_b32 v81, v53, v49, s37
    v_perm_b32 v85, v53, v49, s38
    v_perm_b32 v89, v54, v50, s37
    v_perm_b32 v93, v54, v50, s38
    v_perm_b32 v97, v55, v51, s37
    v_perm_b32 v101, v55, v51, s38
    s_waitcnt vmcnt(2)
    v_perm_b32 v74, v60, v56, s37
    v_perm_b32 v78, v60, v56, s38
    v_perm_b32 v82, v61, v57, s37
    v_perm_b32 v86, v61, v57, s38
    v_perm_b32 v90, v62, v58, s37
    v_perm_b32 v94, v62, v58, s38
    v_perm_b32 v98, v63, v59, s37
    v_perm_b32 v102, v63, v59, s38
    s_waitcnt vmcnt(0)
    v_perm_b32 v75, v68, v64, s37
    v_perm_b32 v79, v68, v64, s38
    v_perm_b32 v83, v69, v65, s37
    v_perm_b32 v87, v69, v65, s38
    v_perm_b32 v91, v70, v66, s37
    v_perm_b32 v95, v70, v66, s38
    v_perm_b32 v99, v71, v67, s37
    v_perm_b32 v103, v71, v67, s38
    s_nop 0
    v_mfma_f32_16x16x32_bf16 v[140:143], v[120:123], v[72:75], v[140:143]
    v_mfma_f32_16x16x32_bf16 v[144:147], v[120:123], v[88:91], v[144:147]
    v_mfma_f32_16x16x32_bf16 v[140:143], v[124:127], v[76:79], v[140:143]
    v_mfma_f32_16x16x32_bf16 v[144:147], v[124:127], v[92:95], v[144:147]
    v_mfma_f32_16x16x32_bf16 v[140:143], v[128:131], v[80:83], v[140:143]
    v_mfma_f32_16x16x32_bf16 v[144:147], v[128:131], v[96:99], v[144:147]
    v_mfma_f32_16x16x32_bf16 v[140:143], v[132:135], v[84:87], v[140:143]
    v_mfma_f32_16x16x32_bf16 v[144:147], v[132:135], v[100:103], v[144:147]
    v_bfe_u32 v48, v1, 3, 1
    v_cmp_eq_u32 vcc, 1, v48
    v_lshrrev_b32 v49, 1, v6
    v_lshl_add_u32 v49, v48, 13, v49
    s_lshl_b32 s37, s29, 14
    s_lshl_b32 s38, s30, 8
    s_add_u32 s37, s37, s38
    s_add_u32 s37, s37, 65536
    s_nop 0
    v_cndmask_b32 v50, v140, v143, vcc
    v_cndmask_b32 v52, v142, v141, vcc
    v_cndmask_b32 v51, v144, v147, vcc
    v_cndmask_b32 v53, v146, v145, vcc
    s_getreg_b32 s70, hwreg(HW_REG_XCC_ID, 0, 3)
    s_xor_b32 s70, s70, s33
    v_add_f32_dpp v50, v52, v50 row_ror:8 row_mask:0xf bank_mask:0xf
    v_add_f32_dpp v51, v53, v51 row_ror:8 row_mask:0xf bank_mask:0xf
    v_bfi_b32 v50, v7, s32, v50
    v_bfi_b32 v51, v7, s70, v51
    s_setprio 3
    buffer_store_dwordx2 v[50:51], v49, s[48:51], s37 offen
    s_setprio 0
    v_mov_b32 v150, 22312
    s_mov_b32 s60, 1048576
L_P0_v:
    ds_read_b32 v151, v150
    s_sub_u32 s60, s60, 1
    s_cbranch_scc1 L_P0_v_x
    s_waitcnt lgkmcnt(0)
    v_cmp_gt_u32 vcc, 8, v151
    s_cbranch_vccnz L_P0_v
L_P0_v_x:
    s_lshl_b32 s62, s31, 17
    s_and_b32 s37, s30, 7
    s_lshl_b32 s37, s37, 7
    s_add_u32 s62, s62, s37
    s_mov_b32 s63, 0x2000
    buffer_load_dwordx4 v[8:11], v5, s[52:55], s62 offen nt
    s_add_u32 s62, s62, s63
    buffer_load_dwordx4 v[12:15], v5, s[52:55], s62 offen nt
    s_add_u32 s62, s62, s63
    buffer_load_dwordx4 v[16:19], v5, s[52:55], s62 offen nt
    s_add_u32 s62, s62, s63
    buffer_load_dwordx4 v[20:23], v5, s[52:55], s62 offen nt
    s_add_u32 s62, s62, s63
    s_mov_b32 s61, s62
    s_and_b32 s37, s30, 7
    s_lshl_b32 s37, s37, 3
    s_lshr_b32 s38, s30, 3
    s_add_u32 s37, s37, s38
    s_lshl_b32 s38, s29, 6
    s_add_u32 s37, s37, s38
    s_lshl_b32 s37, s37, 1
    v_and_b32 v144, 1, v1
    v_lshlrev_b32 v144, 10, v144
    v_bfe_u32 v145, v1, 4, 1
    v_lshl_add_u32 v144, v145, 3, v144
    v_add_u32 v144, s37, v144
    buffer_load_ushort v145, v144, s[40:43], 0 offen
    v_and_b32 v146, 31, v1
    v_lshlrev_b32 v146, 10, v146
    v_lshrrev_b32 v147, 5, v1
    v_lshl_add_u32 v146, v147, 9, v146
    s_lshl_b32 s63, s29, 15
    s_lshl_b32 s37, s30, 4
    s_add_u32 s63, s63, s37
    s_add_u32 s63, s63, 917504
    s_mov_b32 s39, 0xbfb8aa3b
    s_mov_b32 s37, 21504
    v_and_b32 v140, 3, v1
    v_lshlrev_b32 v140, 6, v140
    v_lshrrev_b32 v141, 4, v1
    v_lshl_add_u32 v140, v141, 4, v140
    v_add_u32 v140, s37, v140
    v_bfe_u32 v141, v1, 2, 2
    v_mov_b32 v142, 22528
    v_cmp_eq_u32 vcc, 0, v141
    s_nop 1
    v_cndmask_b32 v136, v142, v140, vcc
    v_cmp_eq_u32 vcc, 1, v141
    s_nop 1
    v_cndmask_b32 v137, v142, v140, vcc
    v_cmp_eq_u32 vcc, 2, v141
    s_nop 1
    v_cndmask_b32 v138, v142, v140, vcc
    v_cmp_eq_u32 vcc, 3, v141
    s_nop 1
    v_cndmask_b32 v139, v142, v140, vcc
    s_and_b32 s37, s30, 7
    s_lshl_b32 s37, s37, 5
    s_add_u32 s37, s37, s31
    s_lshl_b32 s37, s37, 10
    s_add_u32 s62, s37, 917504
    s_waitcnt lgkmcnt(0)
    s_barrier
    s_barrier
    s_setprio 0
    s_mov_b32 s37, 0x05040100
    s_mov_b32 s38, 0x07060302
    s_waitcnt vmcnt(3)
    v_perm_b32 v72, v12, v8, s37
    v_perm_b32 v76, v12, v8, s38
    v_perm_b32 v80, v13, v9, s37
    v_perm_b32 v84, v13, v9, s38
    v_perm_b32 v88, v14, v10, s37
    v_perm_b32 v92, v14, v10, s38
    v_perm_b32 v96, v15, v11, s37
    v_perm_b32 v100, v15, v11, s38
    buffer_load_dwordx4 v[24:27], v5, s[52:55], s61 offen nt
    s_add_u32 s61, s61, 0x2000
    buffer_load_dwordx4 v[28:31], v5, s[52:55], s61 offen nt
    s_add_u32 s61, s61, 0x2000
    buffer_load_dwordx4 v[32:35], v5, s[52:55], s61 offen nt
    s_add_u32 s61, s61, 0x2000
    buffer_load_dwordx4 v[36:39], v5, s[52:55], s61 offen nt
    s_add_u32 s61, s61, 0x2000
    buffer_load_dwordx4 v[40:43], v5, s[52:55], s61 offen nt
    s_add_u32 s61, s61, 0x2000
    buffer_load_dwordx4 v[44:47], v5, s[52:55], s61 offen nt
    s_add_u32 s61, s61, 0x2000
    buffer_load_dwordx4 v[48:51], v5, s[52:55], s61 offen nt
    s_add_u32 s61, s61, 0x2000
    buffer_load_dwordx4 v[52:55], v5, s[52:55], s61 offen nt
    s_add_u32 s61, s61, 0x2000
    buffer_load_dwordx4 v[56:59], v5, s[52:55], s61 offen nt
    s_add_u32 s61, s61, 0x2000
    buffer_load_dwordx4 v[60:63], v5, s[52:55], s61 offen nt
    s_add_u32 s61, s61, 0x2000
    buffer_load_dwordx4 v[64:67], v5, s[52:55], s61 offen nt
    s_add_u32 s61, s61, 0x2000
    buffer_load_dwordx4 v[68:71], v5, s[52:55], s61 offen nt
    s_waitcnt vmcnt(13)
    v_perm_b32 v73, v20, v16, s37
    v_perm_b32 v77, v20, v16, s38
    v_perm_b32 v81, v21, v17, s37
    v_perm_b32 v85, v21, v17, s38
    v_perm_b32 v89, v22, v18, s37
    v_perm_b32 v93, v22, v18, s38
    v_perm_b32 v97, v23, v19, s37
    v_perm_b32 v101, v23, v19, s38
    s_waitcnt vmcnt(10)
    v_perm_b32 v74, v28, v24, s37
    v_perm_b32 v78, v28, v24, s38
    v_perm_b32 v82, v29, v25, s37
    v_perm_b32 v86, v29, v25, s38
    v_perm_b32 v90, v30, v26, s37
    v_perm_b32 v94, v30, v26, s38
    v_perm_b32 v98, v31, v27, s37
    v_perm_b32 v102, v31, v27, s38
    s_waitcnt vmcnt(8)
    v_perm_b32 v75, v36, v32, s37
    v_perm_b32 v79, v36, v32, s38
    v_perm_b32 v83, v37, v33, s37
    v_perm_b32 v87, v37, v33, s38
    v_perm_b32 v91, v38, v34, s37
    v_perm_b32 v95, v38, v34, s38
    v_perm_b32 v99, v39, v35, s37
    v_perm_b32 v103, v39, v35, s38
    s_waitcnt vmcnt(6)
    v_perm_b32 v104, v44, v40, s37
    v_perm_b32 v108, v44, v40, s38
    v_perm_b32 v112, v45, v41, s37
    v_perm_b32 v116, v45, v41, s38
    v_perm_b32 v120, v46, v42, s37
    v_perm_b32 v124, v46, v42, s38
    v_perm_b32 v128, v47, v43, s37
    v_perm_b32 v132, v47, v43, s38
    s_waitcnt vmcnt(4)
    v_perm_b32 v105, v52, v48, s37
    v_perm_b32 v109, v52, v48, s38
    v_perm_b32 v113, v53, v49, s37
    v_perm_b32 v117, v53, v49, s38
    v_perm_b32 v121, v54, v50, s37
    v_perm_b32 v125, v54, v50, s38
    v_perm_b32 v129, v55, v51, s37
    v_perm_b32 v133, v55, v51, s38
    s_waitcnt vmcnt(2)
    v_perm_b32 v106, v60, v56, s37
    v_perm_b32 v110, v60, v56, s38
    v_perm_b32 v114, v61, v57, s37
    v_perm_b32 v118, v61, v57, s38
    v_perm_b32 v122, v62, v58, s37
    v_perm_b32 v126, v62, v58, s38
    v_perm_b32 v130, v63, v59, s37
    v_perm_b32 v134, v63, v59, s38
    s_waitcnt vmcnt(0)
    v_perm_b32 v107, v68, v64, s37
    v_perm_b32 v111, v68, v64, s38
    v_perm_b32 v115, v69, v65, s37
    v_perm_b32 v119, v69, v65, s38
    v_perm_b32 v123, v70, v66, s37
    v_perm_b32 v127, v70, v66, s38
    v_perm_b32 v131, v71, v67, s37
    v_perm_b32 v135, v71, v67, s38
    v_mov_b32 v2, 22300
    ds_read_b32 v2, v2
    s_and_b32 s37, s30, 7
    s_waitcnt lgkmcnt(0)
    v_readfirstlane_b32 s38, v2
    s_xor_b32 s37, s37, s29
    s_or_b32 s61, s37, s38
    s_barrier
    ds_read_b128 v[8:11], v136 offset:0
    ds_read_b128 v[12:15], v137 offset:0
    ds_read_b128 v[16:19], v138 offset:0
    ds_read_b128 v[20:23], v139 offset:0
    ds_read_b128 v[24:27], v136 offset:256
    ds_read_b128 v[28:31], v137 offset:256
    ds_read_b128 v[32:35], v138 offset:256
    ds_read_b128 v[36:39], v139 offset:256
    s_waitcnt lgkmcnt(7)
    v_mfma_f32_16x16x32_bf16 v[40:43], v[8:11], v[72:75], 0
    v_mfma_f32_16x16x32_bf16 v[44:47], v[8:11], v[88:91], 0
    s_waitcnt lgkmcnt(6)
    v_mfma_f32_16x16x32_bf16 v[40:43], v[12:15], v[76:79], v[40:43]
    v_mfma_f32_16x16x32_bf16 v[44:47], v[12:15], v[92:95], v[44:47]
    s_waitcnt lgkmcnt(5)
    v_mfma_f32_16x16x32_bf16 v[40:43], v[16:19], v[80:83], v[40:43]
    v_mfma_f32_16x16x32_bf16 v[44:47], v[16:19], v[96:99], v[44:47]
    s_waitcnt lgkmcnt(4)
    v_mfma_f32_16x16x32_bf16 v[40:43], v[20:23], v[84:87], v[40:43]
    v_mfma_f32_16x16x32_bf16 v[44:47], v[20:23], v[100:103], v[44:47]
    s_waitcnt lgkmcnt(3)
    v_mfma_f32_16x16x32_bf16 v[40:43], v[24:27], v[104:107], v[40:43]
    v_mfma_f32_16x16x32_bf16 v[44:47], v[24:27], v[120:123], v[44:47]
    s_waitcnt lgkmcnt(2)
    v_mfma_f32_16x16x32_bf16 v[40:43], v[28:31], v[108:111], v[40:43]
    v_mfma_f32_16x16x32_bf16 v[44:47], v[28:31], v[124:127], v[44:47]
    s_waitcnt lgkmcnt(1)
    v_mfma_f32_16x16x32_bf16 v[40:43], v[32:35], v[112:115], v[40:43]
    v_mfma_f32_16x16x32_bf16 v[44:47], v[32:35], v[128:131], v[44:47]
    s_waitcnt lgkmcnt(0)
    v_mfma_f32_16x16x32_bf16 v[40:43], v[36:39], v[116:119], v[40:43]
    v_mfma_f32_16x16x32_bf16 v[44:47], v[36:39], v[132:135], v[44:47]
    s_nop 7
    v_add_f32_dpp v48, v41, v40 row_ror:8 row_mask:0xf bank_mask:0xf
    v_add_f32_dpp v49, v43, v42 row_ror:8 row_mask:0xf bank_mask:0xf
    v_add_f32_dpp v50, v45, v44 row_ror:8 row_mask:0xf bank_mask:0xf
    v_add_f32_dpp v51, v47, v46 row_ror:8 row_mask:0xf bank_mask:0xf
    s_mov_b32 exec_lo, 0x00ff00ff
    s_mov_b32 exec_hi, 0x00ff00ff
    v_bfi_b32 v48, v152, s32, v48
    v_bfi_b32 v49, v152, s33, v49
    v_bfi_b32 v50, v152, s34, v50
    v_bfi_b32 v51, v152, s35, v51
    s_cmp_eq_u32 s61, 0
    s_cbranch_scc1 L_P0_sl
    buffer_store_dwordx4 v[48:51], v6, s[48:51], s62 offen sc1
    s_branch L_P0_sd
L_P0_sl:
    buffer_store_dwordx4 v[48:51], v6, s[48:51], s62 offen
L_P0_sd:
    s_mov_b64 exec, -1
    s_mov_b32 s60, 262144
    s_mov_b32 s64, 0xaaaaaaaa
    s_mov_b32 s65, 0xaaaaaaaa
L_P0_c:
    buffer_load_dwordx4 v[8:11], v146, s[48:51], s63 offen sc1
    s_waitcnt vmcnt(0)
    v_xor_b32 v30, s32, v8
    v_bitop3_b32 v30, v30, v9, s33 bitop3:0xf6
    v_bitop3_b32 v30, v30, v10, s34 bitop3:0xf6
    v_bitop3_b32 v30, v30, v11, s35 bitop3:0xf6
    v_and_b32 v30, v30, v152
    v_cmp_ne_u32 vcc, 0, v30
    s_and_b64 exec, exec, vcc
    s_cbranch_execz L_P0_c_0
    s_sub_u32 s60, s60, 1
    s_cbranch_scc0 L_P0_c
L_P0_c_0:
    s_mov_b64 exec, -1
    v_permlane16_swap_b32 v8, v10
    v_permlane16_swap_b32 v9, v11
    v_add_f32 v40, v8, v10
    v_add_f32 v41, v9, v11
L_P0_c_x:
    v_lshlrev_b32 v145, 16, v145
    s_nop 0
    v_add_f32_dpp v40, v40, v40 row_ror:1 row_mask:0xf bank_mask:0xf
    v_add_f32_dpp v41, v41, v41 row_ror:1 row_mask:0xf bank_mask:0xf
    s_nop 0
    v_add_f32_dpp v40, v40, v40 row_ror:2 row_mask:0xf bank_mask:0xf
    v_add_f32_dpp v41, v41, v41 row_ror:2 row_mask:0xf bank_mask:0xf
    s_nop 0
    v_add_f32_dpp v40, v40, v40 row_ror:4 row_mask:0xf bank_mask:0xf
    v_add_f32_dpp v41, v41, v41 row_ror:4 row_mask:0xf bank_mask:0xf
    s_nop 0
    v_add_f32_dpp v40, v40, v40 row_ror:8 row_mask:0xf bank_mask:0xf
    v_add_f32_dpp v41, v41, v41 row_ror:8 row_mask:0xf bank_mask:0xf
    v_cndmask_b32 v40, v40, v41, s[64:65]
    v_cvt_pk_bf16_f32 v40, v40, v40
    v_lshlrev_b32 v40, 16, v40
    v_mov_b32 v41, v40
    s_nop 1
    v_permlane32_swap_b32 v40, v41
    v_mul_f32 v42, s39, v41
    v_exp_f32 v42, v42
    s_nop 0
    v_add_f32 v42, 1.0, v42
    v_rcp_f32 v42, v42
    s_nop 0
    v_mul_f32 v41, v41, v42
    v_cvt_pk_bf16_f32 v41, v41, v41
    v_lshlrev_b32 v41, 16, v41
    v_mul_f32 v40, v40, v41
    v_cvt_pk_bf16_f32 v40, v40, v40
    v_lshlrev_b32 v40, 16, v40
    v_add_f32 v40, v40, v145
    v_cvt_pk_bf16_f32 v40, v40, v40
    s_mov_b64 exec, 0x30003
    buffer_store_short v40, v144, s[56:59], 0 offen
    s_cmp_lg_u32 s2, 0
    s_cbranch_scc1 L_P0_end
    v_mov_b32 v44, s32
    v_mov_b32 v45, s33
    v_mov_b32 v46, s34
    v_mov_b32 v47, s35
    v_mov_b32 v43, 0
    s_mov_b64 exec, 1
    buffer_store_dwordx4 v[44:47], v43, s[48:51], 0 offen offset:0
L_P0_end:
    s_endpgm
L_P1_main:
    v_mov_b32 v7, 0x3f
    v_mov_b32 v152, 0x7ff
    s_lshr_b32 s31, s30, 3
    s_lshl_b32 s37, s29, 2
    s_add_u32 s31, s31, s37
    v_lshl_add_u32 v5, v4, 10, v5
    v_lshrrev_b32 v6, 4, v1
    v_lshlrev_b32 v6, 3, v6
    v_and_b32 v143, 7, v1
    v_add_u32 v6, v6, v143
    v_lshlrev_b32 v6, 4, v6
    s_mov_b32 s48, s26
    s_and_b32 s49, s27, 0xffff
    s_mov_b32 s50, 0x20000000
    s_mov_b32 s51, 0x00020000
    s_waitcnt lgkmcnt(0)
    s_add_u32 s32, s32, 0x2b5
    s_and_b32 s32, s32, 0x7ff
    s_add_u32 s33, s33, 0xd3
    s_and_b32 s33, s33, 0x7ff
    s_add_u32 s34, s34, 0x61f
    s_and_b32 s34, s34, 0x7ff
    s_add_u32 s35, s35, 0x3a9
    s_and_b32 s35, s35, 0x7ff
    s_waitcnt vmcnt(16)
    s_mov_b32 s39, 0xffff0000
    v_lshlrev_b32 v80, 16, v72
    v_and_b32 v81, s39, v72
    v_lshlrev_b32 v82, 16, v73
    v_and_b32 v83, s39, v73
    v_lshlrev_b32 v84, 16, v74
    v_and_b32 v85, s39, v74
    v_lshlrev_b32 v86, 16, v75
    v_and_b32 v87, s39, v75
    v_lshlrev_b32 v88, 16, v76
    v_and_b32 v89, s39, v76
    v_lshlrev_b32 v90, 16, v77
    v_and_b32 v91, s39, v77
    v_lshlrev_b32 v92, 16, v78
    v_and_b32 v93, s39, v78
    v_lshlrev_b32 v94, 16, v79
    v_and_b32 v95, s39, v79
    v_add_f32 v96, v80, v81
    v_add_f32 v97, v88, v89
    v_add_f32 v96, v96, v82
    v_add_f32 v97, v97, v90
    v_add_f32 v96, v96, v83
    v_add_f32 v97, v97, v91
    v_add_f32 v96, v96, v84
    v_add_f32 v97, v97, v92
    v_add_f32 v96, v96, v85
    v_add_f32 v97, v97, v93
    v_add_f32 v96, v96, v86
    v_add_f32 v97, v97, v94
    v_add_f32 v96, v96, v87
    v_add_f32 v97, v97, v95
    s_nop 1
    v_permlane32_swap_b32 v96, v97
    v_add_f32 v96, v96, v97
    v_mov_b32 v98, v96
    s_nop 1
    v_permlane16_swap_b32 v96, v98
    v_add_f32 v96, v96, v98
    s_nop 1
    v_add_f32_dpp v96, v96, v96 row_ror:1 row_mask:0xf bank_mask:0xf
    s_nop 1
    v_add_f32_dpp v96, v96, v96 row_ror:2 row_mask:0xf bank_mask:0xf
    s_nop 1
    v_add_f32_dpp v96, v96, v96 row_ror:4 row_mask:0xf bank_mask:0xf
    s_nop 1
    v_add_f32_dpp v96, v96, v96 row_ror:8 row_mask:0xf bank_mask:0xf
    v_mul_f32 v96, 0x3b000000, v96
    s_nop 0
    v_readlane_b32 s64, v96, 0
    v_readlane_b32 s65, v96, 32
    v_cvt_pk_bf16_f32 v96, v96, v96
    v_lshlrev_b32 v96, 16, v96
    s_nop 0
    v_readlane_b32 s66, v96, 0
    v_readlane_b32 s67, v96, 32
    v_subrev_f32 v98, s64, v80
    v_subrev_f32 v99, s65, v88
    v_mul_f32 v96, v98, v98
    v_mul_f32 v97, v99, v99
    v_subrev_f32 v98, s64, v81
    v_subrev_f32 v99, s65, v89
    v_fmac_f32 v96, v98, v98
    v_fmac_f32 v97, v99, v99
    v_subrev_f32 v98, s64, v82
    v_subrev_f32 v99, s65, v90
    v_fmac_f32 v96, v98, v98
    v_fmac_f32 v97, v99, v99
    v_subrev_f32 v98, s64, v83
    v_subrev_f32 v99, s65, v91
    v_fmac_f32 v96, v98, v98
    v_fmac_f32 v97, v99, v99
    v_subrev_f32 v98, s64, v84
    v_subrev_f32 v99, s65, v92
    v_fmac_f32 v96, v98, v98
    v_fmac_f32 v97, v99, v99
    v_subrev_f32 v98, s64, v85
    v_subrev_f32 v99, s65, v93
    v_fmac_f32 v96, v98, v98
    v_fmac_f32 v97, v99, v99
    v_subrev_f32 v98, s64, v86
    v_subrev_f32 v99, s65, v94
    v_fmac_f32 v96, v98, v98
    v_fmac_f32 v97, v99, v99
    v_subrev_f32 v98, s64, v87
    v_subrev_f32 v99, s65, v95
    v_fmac_f32 v96, v98, v98
    v_fmac_f32 v97, v99, v99
    s_nop 1
    v_permlane32_swap_b32 v96, v97
    v_add_f32 v96, v96, v97
    v_mov_b32 v98, v96
    s_nop 1
    v_permlane16_swap_b32 v96, v98
    v_add_f32 v96, v96, v98
    s_nop 1
    v_add_f32_dpp v96, v96, v96 row_ror:1 row_mask:0xf bank_mask:0xf
    s_nop 1
    v_add_f32_dpp v96, v96, v96 row_ror:2 row_mask:0xf bank_mask:0xf
    s_nop 1
    v_add_f32_dpp v96, v96, v96 row_ror:4 row_mask:0xf bank_mask:0xf
    s_nop 1
    v_add_f32_dpp v96, v96, v96 row_ror:8 row_mask:0xf bank_mask:0xf
    v_mul_f32 v96, 0x3b000000, v96
    v_cvt_pk_bf16_f32 v96, v96, v96
    v_lshlrev_b32 v96, 16, v96
    v_add_f32 v96, 0x3727c5ac, v96
    v_cvt_pk_bf16_f32 v96, v96, v96
    v_lshlrev_b32 v96, 16, v96
    v_sqrt_f32 v96, v96
    s_nop 0
    v_cvt_pk_bf16_f32 v96, v96, v96
    v_lshlrev_b32 v96, 16, v96
    v_rcp_f32 v96, v96
    v_subrev_f32 v80, s66, v80
    v_subrev_f32 v81, s66, v81
    v_subrev_f32 v82, s66, v82
    v_subrev_f32 v83, s66, v83
    v_subrev_f32 v84, s66, v84
    v_subrev_f32 v85, s66, v85
    v_subrev_f32 v86, s66, v86
    v_subrev_f32 v87, s66, v87
    v_subrev_f32 v88, s67, v88
    v_subrev_f32 v89, s67, v89
    v_subrev_f32 v90, s67, v90
    v_subrev_f32 v91, s67, v91
    v_subrev_f32 v92, s67, v92
    v_subrev_f32 v93, s67, v93
    v_subrev_f32 v94, s67, v94
    v_subrev_f32 v95, s67, v95
    v_readlane_b32 s68, v96, 0
    v_readlane_b32 s69, v96, 32
    v_cvt_pk_bf16_f32 v72, v80, v81
    v_cvt_pk_bf16_f32 v73, v82, v83
    v_cvt_pk_bf16_f32 v74, v84, v85
    v_cvt_pk_bf16_f32 v75, v86, v87
    v_cvt_pk_bf16_f32 v76, v88, v89
    v_cvt_pk_bf16_f32 v77, v90, v91
    v_cvt_pk_bf16_f32 v78, v92, v93
    v_cvt_pk_bf16_f32 v79, v94, v95
    v_lshlrev_b32 v80, 16, v72
    v_and_b32 v81, s39, v72
    v_lshlrev_b32 v82, 16, v73
    v_and_b32 v83, s39, v73
    v_lshlrev_b32 v84, 16, v74
    v_and_b32 v85, s39, v74
    v_lshlrev_b32 v86, 16, v75
    v_and_b32 v87, s39, v75
    v_lshlrev_b32 v88, 16, v76
    v_and_b32 v89, s39, v76
    v_lshlrev_b32 v90, 16, v77
    v_and_b32 v91, s39, v77
    v_lshlrev_b32 v92, 16, v78
    v_and_b32 v93, s39, v78
    v_lshlrev_b32 v94, 16, v79
    v_and_b32 v95, s39, v79
    v_mul_f32 v80, s68, v80
    v_mul_f32 v81, s68, v81
    v_mul_f32 v82, s68, v82
    v_mul_f32 v83, s68, v83
    v_mul_f32 v84, s68, v84
    v_mul_f32 v85, s68, v85
    v_mul_f32 v86, s68, v86
    v_mul_f32 v87, s68, v87
    v_mul_f32 v88, s69, v88
    v_mul_f32 v89, s69, v89
    v_mul_f32 v90, s69, v90
    v_mul_f32 v91, s69, v91
    v_mul_f32 v92, s69, v92
    v_mul_f32 v93, s69, v93
    v_mul_f32 v94, s69, v94
    v_mul_f32 v95, s69, v95
    v_lshrrev_b32 v96, 3, v1
    v_lshlrev_b32 v96, 8, v96
    v_and_b32 v97, 7, v1
    v_lshl_add_u32 v96, v97, 1, v96
    v_cvt_pk_bf16_f32 v72, v80, v81
    v_cvt_pk_bf16_f32 v73, v82, v83
    v_cvt_pk_bf16_f32 v74, v84, v85
    v_cvt_pk_bf16_f32 v75, v86, v87
    v_cvt_pk_bf16_f32 v76, v88, v89
    v_cvt_pk_bf16_f32 v77, v90, v91
    v_cvt_pk_bf16_f32 v78, v92, v93
    v_cvt_pk_bf16_f32 v79, v94, v95
    ds_write_b16 v96, v72 offset:19456
    ds_write_b16_d16_hi v96, v72 offset:19520
    ds_write_b16 v96, v73 offset:19472
    ds_write_b16_d16_hi v96, v73 offset:19536
    ds_write_b16 v96, v74 offset:19488
    ds_write_b16_d16_hi v96, v74 offset:19552
    ds_write_b16 v96, v75 offset:19504
    ds_write_b16_d16_hi v96, v75 offset:19568
    ds_write_b16 v96, v76 offset:19584
    ds_write_b16_d16_hi v96, v76 offset:19648
    ds_write_b16 v96, v77 offset:19600
    ds_write_b16_d16_hi v96, v77 offset:19664
    ds_write_b16 v96, v78 offset:19616
    ds_write_b16_d16_hi v96, v78 offset:19680
    ds_write_b16 v96, v79 offset:19632
    ds_write_b16_d16_hi v96, v79 offset:19696
    s_lshl_b32 s37, s61, 9
    s_add_u32 s37, s37, 19456
    v_and_b32 v140, 3, v1
    v_lshlrev_b32 v140, 6, v140
    v_lshrrev_b32 v141, 4, v1
    v_lshl_add_u32 v140, v141, 4, v140
    v_add_u32 v140, s37, v140
    v_bfe_u32 v141, v1, 2, 2
    v_mov_b32 v142, 22528
    v_cmp_eq_u32 vcc, 0, v141
    s_nop 1
    v_cndmask_b32 v136, v142, v140, vcc
    v_cmp_eq_u32 vcc, 1, v141
    s_nop 1
    v_cndmask_b32 v137, v142, v140, vcc
    v_cmp_eq_u32 vcc, 2, v141
    s_nop 1
    v_cndmask_b32 v138, v142, v140, vcc
    v_cmp_eq_u32 vcc, 3, v141
    s_nop 1
    v_cndmask_b32 v139, v142, v140, vcc
    s_waitcnt lgkmcnt(0)
    ds_read_b128 v[104:107], v136 offset:0
    ds_read_b128 v[108:111], v137 offset:0
    ds_read_b128 v[112:115], v138 offset:0
    ds_read_b128 v[116:119], v139 offset:0
    ds_read_b128 v[120:123], v136 offset:256
    ds_read_b128 v[124:127], v137 offset:256
    ds_read_b128 v[128:131], v138 offset:256
    ds_read_b128 v[132:135], v139 offset:256
    s_mov_b32 s37, 0x05040100
    s_mov_b32 s38, 0x07060302
    s_waitcnt vmcnt(14)
    v_perm_b32 v72, v12, v8, s37
    v_perm_b32 v76, v12, v8, s38
    v_perm_b32 v80, v13, v9, s37
    v_perm_b32 v84, v13, v9, s38
    v_perm_b32 v88, v14, v10, s37
    v_perm_b32 v92, v14, v10, s38
    v_perm_b32 v96, v15, v11, s37
    v_perm_b32 v100, v15, v11, s38
    s_waitcnt vmcnt(12)
    v_perm_b32 v73, v20, v16, s37
    v_perm_b32 v77, v20, v16, s38
    v_perm_b32 v81, v21, v17, s37
    v_perm_b32 v85, v21, v17, s38
    v_perm_b32 v89, v22, v18, s37
    v_perm_b32 v93, v22, v18, s38
    v_perm_b32 v97, v23, v19, s37
    v_perm_b32 v101, v23, v19, s38
    s_waitcnt vmcnt(10)
    v_perm_b32 v74, v28, v24, s37
    v_perm_b32 v78, v28, v24, s38
    v_perm_b32 v82, v29, v25, s37
    v_perm_b32 v86, v29, v25, s38
    v_perm_b32 v90, v30, v26, s37
    v_perm_b32 v94, v30, v26, s38
    v_perm_b32 v98, v31, v27, s37
    v_perm_b32 v102, v31, v27, s38
    s_waitcnt vmcnt(8)
    v_perm_b32 v75, v36, v32, s37
    v_perm_b32 v79, v36, v32, s38
    v_perm_b32 v83, v37, v33, s37
    v_perm_b32 v87, v37, v33, s38
    v_perm_b32 v91, v38, v34, s37
    v_perm_b32 v95, v38, v34, s38
    v_perm_b32 v99, v39, v35, s37
    v_perm_b32 v103, v39, v35, s38
    s_waitcnt lgkmcnt(0)
    v_mfma_f32_16x16x32_bf16 v[140:143], v[104:107], v[72:75], 0
    v_mfma_f32_16x16x32_bf16 v[144:147], v[104:107], v[88:91], 0
    v_mfma_f32_16x16x32_bf16 v[140:143], v[108:111], v[76:79], v[140:143]
    v_mfma_f32_16x16x32_bf16 v[144:147], v[108:111], v[92:95], v[144:147]
    v_mfma_f32_16x16x32_bf16 v[140:143], v[112:115], v[80:83], v[140:143]
    v_mfma_f32_16x16x32_bf16 v[144:147], v[112:115], v[96:99], v[144:147]
    v_mfma_f32_16x16x32_bf16 v[140:143], v[116:119], v[84:87], v[140:143]
    v_mfma_f32_16x16x32_bf16 v[144:147], v[116:119], v[100:103], v[144:147]
    s_waitcnt vmcnt(6)
    v_perm_b32 v72, v44, v40, s37
    v_perm_b32 v76, v44, v40, s38
    v_perm_b32 v80, v45, v41, s37
    v_perm_b32 v84, v45, v41, s38
    v_perm_b32 v88, v46, v42, s37
    v_perm_b32 v92, v46, v42, s38
    v_perm_b32 v96, v47, v43, s37
    v_perm_b32 v100, v47, v43, s38
    s_waitcnt vmcnt(4)
    v_perm_b32 v73, v52, v48, s37
    v_perm_b32 v77, v52, v48, s38
    v_perm_b32 v81, v53, v49, s37
    v_perm_b32 v85, v53, v49, s38
    v_perm_b32 v89, v54, v50, s37
    v_perm_b32 v93, v54, v50, s38
    v_perm_b32 v97, v55, v51, s37
    v_perm_b32 v101, v55, v51, s38
    s_waitcnt vmcnt(2)
    v_perm_b32 v74, v60, v56, s37
    v_perm_b32 v78, v60, v56, s38
    v_perm_b32 v82, v61, v57, s37
    v_perm_b32 v86, v61, v57, s38
    v_perm_b32 v90, v62, v58, s37
    v_perm_b32 v94, v62, v58, s38
    v_perm_b32 v98, v63, v59, s37
    v_perm_b32 v102, v63, v59, s38
    s_waitcnt vmcnt(0)
    v_perm_b32 v75, v68, v64, s37
    v_perm_b32 v79, v68, v64, s38
    v_perm_b32 v83, v69, v65, s37
    v_perm_b32 v87, v69, v65, s38
    v_perm_b32 v91, v70, v66, s37
    v_perm_b32 v95, v70, v66, s38
    v_perm_b32 v99, v71, v67, s37
    v_perm_b32 v103, v71, v67, s38
    s_nop 0
    v_mfma_f32_16x16x32_bf16 v[140:143], v[120:123], v[72:75], v[140:143]
    v_mfma_f32_16x16x32_bf16 v[144:147], v[120:123], v[88:91], v[144:147]
    v_mfma_f32_16x16x32_bf16 v[140:143], v[124:127], v[76:79], v[140:143]
    v_mfma_f32_16x16x32_bf16 v[144:147], v[124:127], v[92:95], v[144:147]
    v_mfma_f32_16x16x32_bf16 v[140:143], v[128:131], v[80:83], v[140:143]
    v_mfma_f32_16x16x32_bf16 v[144:147], v[128:131], v[96:99], v[144:147]
    v_mfma_f32_16x16x32_bf16 v[140:143], v[132:135], v[84:87], v[140:143]
    v_mfma_f32_16x16x32_bf16 v[144:147], v[132:135], v[100:103], v[144:147]
    v_mov_b32 v150, 22272
    s_mov_b32 s60, 1048576
L_P1_f:
    ds_read_b32 v151, v150 offset:20
    ds_read_b32 v149, v150 offset:28
    s_sub_u32 s60, s60, 1
    s_cbranch_scc1 L_P1_f_x
    s_waitcnt lgkmcnt(0)
    v_cmp_ne_u32 vcc, 8, v151
    s_cbranch_vccnz L_P1_f
L_P1_f_x:
    v_cmp_eq_u32 s[64:65], 0, v149
    s_nop 7
    v_add_f32_dpp v48, v141, v140 row_ror:8 row_mask:0xf bank_mask:0xf
    v_add_f32_dpp v49, v143, v142 row_ror:8 row_mask:0xf bank_mask:0xf
    v_add_f32_dpp v50, v145, v144 row_ror:8 row_mask:0xf bank_mask:0xf
    v_add_f32_dpp v51, v147, v146 row_ror:8 row_mask:0xf bank_mask:0xf
    s_mov_b32 exec_lo, 0x00ff00ff
    s_mov_b32 exec_hi, 0x00ff00ff
    v_bfi_b32 v48, v7, s32, v48
    v_bfi_b32 v49, v7, s33, v49
    v_bfi_b32 v50, v7, s34, v50
    v_bfi_b32 v51, v7, s35, v51
    s_lshl_b32 s37, s29, 5
    s_add_u32 s37, s37, s30
    s_lshl_b32 s37, s37, 9
    s_add_u32 s37, s37, 196608
    s_cmp_lg_u64 s[64:65], 0
    s_cbranch_scc1 L_P1_gfast
    buffer_store_dwordx4 v[48:51], v6, s[48:51], s37 offen sc1
    s_branch L_P1_gdone
L_P1_gfast:
    buffer_store_dwordx4 v[48:51], v6, s[48:51], s37 offen
L_P1_gdone:
    s_mov_b64 exec, -1
    s_branch L_P1_tail
L_P1_nogu:
    v_mov_b32 v7, 0x3f
    v_mov_b32 v152, 0x7ff
    s_lshr_b32 s31, s30, 3
    s_lshl_b32 s37, s29, 2
    s_add_u32 s31, s31, s37
    v_lshl_add_u32 v5, v4, 10, v5
    v_lshrrev_b32 v6, 4, v1
    v_lshlrev_b32 v6, 3, v6
    v_and_b32 v143, 7, v1
    v_add_u32 v6, v6, v143
    v_lshlrev_b32 v6, 4, v6
    s_mov_b32 s48, s26
    s_and_b32 s49, s27, 0xffff
    s_mov_b32 s50, 0x20000000
    s_mov_b32 s51, 0x00020000
    s_waitcnt lgkmcnt(0)
    s_add_u32 s32, s32, 0x2b5
    s_and_b32 s32, s32, 0x7ff
    s_add_u32 s33, s33, 0xd3
    s_and_b32 s33, s33, 0x7ff
    s_add_u32 s34, s34, 0x61f
    s_and_b32 s34, s34, 0x7ff
    s_add_u32 s35, s35, 0x3a9
    s_and_b32 s35, s35, 0x7ff
L_P1_tail:
    s_setprio 0
    v_mov_b32 v150, 22308
    s_mov_b32 s60, 1048576
L_P1_v:
    ds_read_b32 v151, v150
    s_sub_u32 s60, s60, 1
    s_cbranch_scc1 L_P1_v_x
    s_waitcnt lgkmcnt(0)
    v_cmp_gt_u32 vcc, 8, v151
    s_cbranch_vccnz L_P1_v
L_P1_v_x:
    s_mov_b32 s52, s20
    s_and_b32 s53, s21, 0xffff
    s_mov_b32 s54, 0x1c0000
    s_mov_b32 s55, 0x00020000
    s_lshr_b32 s59, s30, 3
    s_mul_i32 s59, s59, s57
    s_lshl_b32 s59, s59, 1
    s_lshl3_add_u32 s62, s56, s59
    s_lshl_b32 s62, s62, 13
    s_and_b32 s37, s30, 7
    s_lshl_b32 s37, s37, 7
    s_add_u32 s62, s62, s37
    s_cmp_lt_u32 s57, 4
    s_cselect_b32 s58, 0x40000000, 0
    v_add_u32 v148, s58, v5
    s_cmp_lt_u32 s57, 3
    s_cselect_b32 s58, 0x40000000, 0
    v_add_u32 v147, s58, v5
    s_mov_b32 s61, s62
    buffer_load_dwordx4 v[8:11], v5, s[52:55], s61 offen nt
    s_add_u32 s61, s61, 0x2000
    buffer_load_dwordx4 v[12:15], v5, s[52:55], s61 offen nt
    s_add_u32 s61, s61, 0x2000
    buffer_load_dwordx4 v[16:19], v5, s[52:55], s61 offen nt
    s_add_u32 s61, s61, 0x2000
    buffer_load_dwordx4 v[20:23], v5, s[52:55], s61 offen nt
    s_add_u32 s61, s61, 0x2000
    buffer_load_dwordx4 v[24:27], v147, s[52:55], s61 offen nt
    s_add_u32 s61, s61, 0x2000
    buffer_load_dwordx4 v[28:31], v147, s[52:55], s61 offen nt
    s_add_u32 s61, s61, 0x2000
    buffer_load_dwordx4 v[32:35], v148, s[52:55], s61 offen nt
    s_add_u32 s61, s61, 0x2000
    buffer_load_dwordx4 v[36:39], v148, s[52:55], s61 offen nt
    s_lshl_b32 s37, s57, 1
    s_sub_u32 s37, s37, 1
    v_and_b32 v3, 7, v1
    v_min_u32 v3, s37, v3
    v_add_u32 v4, s59, v3
    v_bfe_u32 v2, v1, 3, 2
    v_lshrrev_b32 v60, 3, v4
    v_lshrrev_b32 v61, 5, v1
    v_lshl_add_u32 v60, v61, 2, v60
    v_lshlrev_b32 v60, 11, v60
    v_and_b32 v4, 7, v4
    v_lshl_add_u32 v60, v4, 4, v60
    v_lshl_add_u32 v60, v2, 7, v60
    v_and_b32 v61, 1, v2
    v_lshlrev_b32 v61, 6, v61
    v_lshrrev_b32 v4, 1, v2
    v_lshl_add_u32 v61, v4, 4, v61
    v_lshl_add_u32 v61, v3, 1, v61
    v_add_u32 v61, 22016, v61
    s_lshl_b32 s63, s29, 14
    s_add_u32 s63, s63, 196608
    buffer_load_dwordx4 v[40:43], v60, s[48:51], s63 offen offset:0 sc1
    buffer_load_dwordx4 v[44:47], v60, s[48:51], s63 offen offset:512 sc1
    buffer_load_dwordx4 v[48:51], v60, s[48:51], s63 offen offset:1024 sc1
    buffer_load_dwordx4 v[52:55], v60, s[48:51], s63 offen offset:1536 sc1
    s_mov_b32 s37, 22016
    v_and_b32 v140, 3, v1
    v_lshlrev_b32 v140, 6, v140
    v_lshrrev_b32 v141, 4, v1
    v_lshl_add_u32 v140, v141, 4, v140
    v_add_u32 v140, s37, v140
    v_bfe_u32 v141, v1, 2, 2
    v_mov_b32 v142, 22528
    v_cmp_eq_u32 vcc, 0, v141
    s_nop 1
    v_cndmask_b32 v136, v142, v140, vcc
    v_cmp_eq_u32 vcc, 1, v141
    s_nop 1
    v_cndmask_b32 v137, v142, v140, vcc
    v_cmp_eq_u32 vcc, 2, v141
    s_nop 1
    v_cndmask_b32 v138, v142, v140, vcc
    v_cmp_eq_u32 vcc, 3, v141
    s_nop 1
    v_cndmask_b32 v139, v142, v140, vcc
    s_and_b32 s37, s30, 7
    s_lshl_b32 s37, s37, 5
    s_add_u32 s37, s37, s31
    s_lshl_b32 s37, s37, 10
    s_add_u32 s62, s37, 918016
    s_mov_b32 s39, 0xbfb8aa3b
    s_barrier
    s_barrier
    s_setprio 2
    s_mov_b32 s37, 0x05040100
    s_mov_b32 s38, 0x07060302
    s_waitcnt vmcnt(4)
    v_perm_b32 v72, v12, v8, s37
    v_perm_b32 v76, v12, v8, s38
    v_perm_b32 v80, v13, v9, s37
    v_perm_b32 v84, v13, v9, s38
    v_perm_b32 v88, v14, v10, s37
    v_perm_b32 v92, v14, v10, s38
    v_perm_b32 v96, v15, v11, s37
    v_perm_b32 v100, v15, v11, s38
    v_perm_b32 v73, v20, v16, s37
    v_perm_b32 v77, v20, v16, s38
    v_perm_b32 v81, v21, v17, s37
    v_perm_b32 v85, v21, v17, s38
    v_perm_b32 v89, v22, v18, s37
    v_perm_b32 v93, v22, v18, s38
    v_perm_b32 v97, v23, v19, s37
    v_perm_b32 v101, v23, v19, s38
    v_perm_b32 v74, v28, v24, s37
    v_perm_b32 v78, v28, v24, s38
    v_perm_b32 v82, v29, v25, s37
    v_perm_b32 v86, v29, v25, s38
    v_perm_b32 v90, v30, v26, s37
    v_perm_b32 v94, v30, v26, s38
    v_perm_b32 v98, v31, v27, s37
    v_perm_b32 v102, v31, v27, s38
    v_perm_b32 v75, v36, v32, s37
    v_perm_b32 v79, v36, v32, s38
    v_perm_b32 v83, v37, v33, s37
    v_perm_b32 v87, v37, v33, s38
    v_perm_b32 v91, v38, v34, s37
    v_perm_b32 v95, v38, v34, s38
    v_perm_b32 v99, v39, v35, s37
    v_perm_b32 v103, v39, v35, s38
    s_mov_b32 s60, 262144
L_P1_h:
    s_waitcnt vmcnt(0)
L_P1_h1:
    v_xor_b32 v56, s32, v40
    v_bitop3_b32 v56, v56, v41, s33 bitop3:0xf6
    v_bitop3_b32 v56, v56, v42, s34 bitop3:0xf6
    v_bitop3_b32 v56, v56, v43, s35 bitop3:0xf6
    v_bitop3_b32 v56, v56, v44, s32 bitop3:0xf6
    v_bitop3_b32 v56, v56, v45, s33 bitop3:0xf6
    v_bitop3_b32 v56, v56, v46, s34 bitop3:0xf6
    v_bitop3_b32 v56, v56, v47, s35 bitop3:0xf6
    v_bitop3_b32 v56, v56, v48, s32 bitop3:0xf6
    v_bitop3_b32 v56, v56, v49, s33 bitop3:0xf6
    v_bitop3_b32 v56, v56, v50, s34 bitop3:0xf6
    v_bitop3_b32 v56, v56, v51, s35 bitop3:0xf6
    v_bitop3_b32 v56, v56, v52, s32 bitop3:0xf6
    v_bitop3_b32 v56, v56, v53, s33 bitop3:0xf6
    v_bitop3_b32 v56, v56, v54, s34 bitop3:0xf6
    v_bitop3_b32 v56, v56, v55, s35 bitop3:0xf6
    v_and_b32 v56, v56, v7
    v_cmp_ne_u32 vcc, 0, v56
    s_cbranch_vccz L_P1_h_x
    s_sub_u32 s60, s60, 1
    s_cbranch_scc1 L_P1_h_x
    buffer_load_dwordx4 v[40:43], v60, s[48:51], s63 offen offset:0 sc1
    buffer_load_dwordx4 v[44:47], v60, s[48:51], s63 offen offset:512 sc1
    buffer_load_dwordx4 v[48:51], v60, s[48:51], s63 offen offset:1024 sc1
    buffer_load_dwordx4 v[52:55], v60, s[48:51], s63 offen offset:1536 sc1
    s_branch L_P1_h
L_P1_h_x:
    v_pk_add_f32 v[40:41], v[40:41], v[44:45]
    v_pk_add_f32 v[48:49], v[48:49], v[52:53]
    v_pk_add_f32 v[40:41], v[40:41], v[48:49]
    v_pk_add_f32 v[42:43], v[42:43], v[46:47]
    v_pk_add_f32 v[50:51], v[50:51], v[54:55]
    v_pk_add_f32 v[42:43], v[42:43], v[50:51]
    v_cvt_pk_bf16_f32 v40, v40, v40
    v_lshlrev_b32 v40, 16, v40
    v_cvt_pk_bf16_f32 v41, v41, v41
    v_lshlrev_b32 v41, 16, v41
    v_cvt_pk_bf16_f32 v42, v42, v42
    v_lshlrev_b32 v42, 16, v42
    v_cvt_pk_bf16_f32 v43, v43, v43
    v_lshlrev_b32 v43, 16, v43
    v_mov_b32 v44, v40
    v_mov_b32 v45, v41
    v_mov_b32 v46, v42
    v_mov_b32 v47, v43
    s_nop 0
    v_permlane32_swap_b32 v40, v44
    v_permlane32_swap_b32 v41, v45
    v_permlane32_swap_b32 v42, v46
    v_permlane32_swap_b32 v43, v47
    v_mul_f32 v48, s39, v40
    v_mul_f32 v49, s39, v41
    v_mul_f32 v50, s39, v42
    v_mul_f32 v51, s39, v43
    v_exp_f32 v48, v48
    v_exp_f32 v49, v49
    v_exp_f32 v50, v50
    v_exp_f32 v51, v51
    v_add_f32 v48, 1.0, v48
    v_add_f32 v49, 1.0, v49
    v_add_f32 v50, 1.0, v50
    v_add_f32 v51, 1.0, v51
    v_rcp_f32 v48, v48
    v_rcp_f32 v49, v49
    v_rcp_f32 v50, v50
    v_rcp_f32 v51, v51
    v_mul_f32 v40, v40, v48
    v_mul_f32 v41, v41, v49
    v_mul_f32 v42, v42, v50
    v_mul_f32 v43, v43, v51
    v_cvt_pk_bf16_f32 v40, v40, v40
    v_lshlrev_b32 v40, 16, v40
    v_cvt_pk_bf16_f32 v41, v41, v41
    v_lshlrev_b32 v41, 16, v41
    v_cvt_pk_bf16_f32 v42, v42, v42
    v_lshlrev_b32 v42, 16, v42
    v_cvt_pk_bf16_f32 v43, v43, v43
    v_lshlrev_b32 v43, 16, v43
    v_mul_f32 v40, v40, v44
    v_mul_f32 v41, v41, v45
    v_mul_f32 v42, v42, v46
    v_mul_f32 v43, v43, v47
    v_cvt_pk_bf16_f32 v40, v40, v40
    v_cvt_pk_bf16_f32 v41, v41, v41
    v_cvt_pk_bf16_f32 v42, v42, v42
    v_cvt_pk_bf16_f32 v43, v43, v43
    ds_write_b16 v61, v40 offset:0
    ds_write_b16 v61, v41 offset:128
    ds_write_b16 v61, v42 offset:32
    ds_write_b16 v61, v43 offset:160
    s_waitcnt lgkmcnt(0)
    ds_read_b128 v[8:11], v136 offset:0
    ds_read_b128 v[12:15], v137 offset:0
    ds_read_b128 v[16:19], v138 offset:0
    ds_read_b128 v[20:23], v139 offset:0
    s_waitcnt lgkmcnt(3)
    v_mfma_f32_16x16x32_bf16 v[40:43], v[8:11], v[72:75], 0
    v_mfma_f32_16x16x32_bf16 v[44:47], v[8:11], v[88:91], 0
    s_waitcnt lgkmcnt(2)
    v_mfma_f32_16x16x32_bf16 v[40:43], v[12:15], v[76:79], v[40:43]
    v_mfma_f32_16x16x32_bf16 v[44:47], v[12:15], v[92:95], v[44:47]
    s_waitcnt lgkmcnt(1)
    v_mfma_f32_16x16x32_bf16 v[40:43], v[16:19], v[80:83], v[40:43]
    v_mfma_f32_16x16x32_bf16 v[44:47], v[16:19], v[96:99], v[44:47]
    s_waitcnt lgkmcnt(0)
    v_mfma_f32_16x16x32_bf16 v[40:43], v[20:23], v[84:87], v[40:43]
    v_mfma_f32_16x16x32_bf16 v[44:47], v[20:23], v[100:103], v[44:47]
    s_nop 7
    v_add_f32_dpp v48, v41, v40 row_ror:8 row_mask:0xf bank_mask:0xf
    v_add_f32_dpp v49, v43, v42 row_ror:8 row_mask:0xf bank_mask:0xf
    v_add_f32_dpp v50, v45, v44 row_ror:8 row_mask:0xf bank_mask:0xf
    v_add_f32_dpp v51, v47, v46 row_ror:8 row_mask:0xf bank_mask:0xf
    s_mov_b32 exec_lo, 0x00ff00ff
    s_mov_b32 exec_hi, 0x00ff00ff
    v_bfi_b32 v48, v152, s32, v48
    v_bfi_b32 v49, v152, s33, v49
    v_bfi_b32 v50, v152, s34, v50
    v_bfi_b32 v51, v152, s35, v51
    buffer_store_dwordx4 v[48:51], v6, s[48:51], s62 offen sc1
    s_barrier
L_end:
    s_endpgm
L_codeend:
s_endpgm
.section .rodata,"a"
.p2align 6
.amdhsa_kernel recurrent_scan__sliding_block_cached__swiglu_ffn__decode_kernel
  .amdhsa_next_free_vgpr 160
  .amdhsa_next_free_sgpr 100
  .amdhsa_accum_offset 160
  .amdhsa_group_segment_fixed_size 0
  .amdhsa_kernarg_size 96
  .amdhsa_user_sgpr_count 2
  .amdhsa_user_sgpr_kernarg_segment_ptr 1
  .amdhsa_system_sgpr_workgroup_id_x 1
.end_amdhsa_kernel
```
